```python
import torch

def _softmax(x, axis=-1):
    return torch.softmax(x, dim=axis)
def _gelu(x):
    return torch.nn.functional.gelu(x, approximate="tanh")
def _silu(x):
    return torch.nn.functional.silu(x)
def _sigmoid(x):
    return torch.sigmoid(x)
def _layernorm(x, axis=-1, eps=1e-5):
    m = x.mean(dim=axis, keepdim=True)
    v = x.var(dim=axis, keepdim=True, unbiased=False)
    return (x - m) / torch.sqrt(v + eps)
def _scatter_add(tgt, idx, src, axis=0):
    return tgt.clone().index_add_(axis, idx, src)
def _segment_sum(src, seg, n):
    out = torch.zeros((n,) + src.shape[1:], dtype=src.dtype)
    return out.index_add_(0, seg, src)
def _pad(x, pw):
    flat = tuple(v for pair in reversed(pw) for v in pair)
    return torch.nn.functional.pad(x, flat)

kernel_name = 'gated_mix__ssm_conv_s5__glu_gated_swiglu__prompt'

def setup_inputs():

    _w = (lambda a: (lambda t: t.to(torch.bfloat16) if t.is_floating_point() else t)(torch.as_tensor(a)))
    def _A_setup():
        B, S, D = 1, 2048, 1024
        P = D
        Lambda_re = -0.5 * (lambda _x: torch.exp(torch.as_tensor(_x)))((lambda *s: torch.randn(*s, dtype=torch.bfloat16) * 0.2)(P))
        Lambda_im = (lambda *s: torch.randn(*s, dtype=torch.bfloat16) * 0.4)(P) * 1.0
        B_re = (lambda *s: torch.randn(*s, dtype=torch.bfloat16) * 0.2)(P, D) * (D ** -0.5)
        B_im = (lambda *s: torch.randn(*s, dtype=torch.bfloat16) * 0.2)(P, D) * (D ** -0.5)
        C_re = (lambda *s: torch.randn(*s, dtype=torch.bfloat16) * 0.2)(D, P) * (P ** -0.5)
        C_im = (lambda *s: torch.randn(*s, dtype=torch.bfloat16) * 0.2)(D, P) * (P ** -0.5)
        log_dt = (lambda *s: torch.randn(*s, dtype=torch.bfloat16) * 0.2)(P) * 0.3 - 2.0
        Dskip = (lambda *s: torch.randn(*s, dtype=torch.bfloat16) * 0.05)(D)
        return {
            "x": _w((lambda *s: torch.randn(*s, dtype=torch.bfloat16) * 0.05)(B, S, D)),
            "Lambda_re": _w(Lambda_re),
            "Lambda_im": _w(Lambda_im),
            "B_re": _w(B_re),
            "B_im": _w(B_im),
            "C_re": _w(C_re),
            "C_im": _w(C_im),
            "log_dt": _w(log_dt),
            "Dskip": _w(Dskip),
        }
    _A_in = _A_setup()

    def _B_setup():
        B, S, D, F = 1, 2048, 1024, 3584
        return {
            "x": _w((lambda *s: torch.randn(*s, dtype=torch.bfloat16) * 0.05)(B, S, D)),
            "w1": _w((lambda *s: torch.randn(*s, dtype=torch.bfloat16) * 0.8)(D, F) * (2.0 / D) ** 0.5),
            "w3": _w((lambda *s: torch.randn(*s, dtype=torch.bfloat16) * 0.8)(D, F) * (2.0 / D) ** 0.5),
            "w2": _w((lambda *s: torch.randn(*s, dtype=torch.bfloat16) * 0.8)(F, D) * (2.0 / F) ** 0.5),
        }
    _B_in = _B_setup()

    return {
        "A_x": _A_in["x"],
        "A_Lambda_re": _A_in["Lambda_re"],
        "A_Lambda_im": _A_in["Lambda_im"],
        "A_B_re": _A_in["B_re"],
        "A_B_im": _A_in["B_im"],
        "A_C_re": _A_in["C_re"],
        "A_C_im": _A_in["C_im"],
        "A_log_dt": _A_in["log_dt"],
        "A_Dskip": _A_in["Dskip"],
        "B_x": _B_in["x"],
        "B_w1": _B_in["w1"],
        "B_w3": _B_in["w3"],
        "B_w2": _B_in["w2"],
        "gate_w": _w((lambda *s: torch.randn(*s, dtype=torch.bfloat16) * 0.05)(1024) * 16.0),
    }

def reference(A_x, A_Lambda_re, A_Lambda_im, A_B_re, A_B_im, A_C_re, A_C_im, A_log_dt, A_Dskip, B_x, B_w1, B_w3, B_w2, gate_w):
    def _A_ref(x, Lambda_re, Lambda_im, B_re, B_im, C_re, C_im, log_dt, Dskip):
        Bsz, L, H = x.shape
        Lam = Lambda_re + 1j * Lambda_im
        Bmat = B_re + 1j * B_im
        Cmat = C_re + 1j * C_im
        dt = torch.exp(log_dt)
        Lam_bar = torch.exp(dt * Lam)
        B_bar = ((Lam_bar - 1.0) / Lam)[:, None] * Bmat
        Bu = torch.einsum("bld,pd->blp", x + 0j, B_bar)
        h = torch.zeros_like(Bu[:, 0, :])
        hs = []
        for t in range(L):
            h = Lam_bar[None, :] * h + Bu[:, t, :]
            hs.append(h)
        hseq = torch.stack(hs, 1)
        y = 2.0 * torch.einsum("blp,dp->bld", hseq, Cmat).real + x * Dskip[None, None, :]
        return y

    def _B_ref(x, w1, w3, w2):
        gate = torch.einsum("bsd,df->bsf", x, w1)
        up = torch.einsum("bsd,df->bsf", x, w3)
        h = _silu(gate) * up
        out = torch.einsum("bsf,fd->bsd", h, w2)
        return out

    x = A_x
    g = _sigmoid((x * gate_w).sum(-1, keepdims=True))
    a = _A_ref(x, A_Lambda_re, A_Lambda_im, A_B_re, A_B_im, A_C_re, A_C_im, A_log_dt, A_Dskip)
    b = _B_ref(x, B_w1, B_w3, B_w2)
    return g * a + (1 - g) * b
```

```asm
; @launch kernel=gm_phase1_kernel grid=(256,1,1) block=(256,1,1) lds=139264
; @launch kernel=gm_phase2_kernel grid=(256,1,1) block=(256,1,1) lds=163840
.amdgcn_target "amdgcn-amd-amdhsa--gfx950"
.text
.globl gm_phase1_kernel
.p2align 8
.type gm_phase1_kernel,@function
gm_phase1_kernel:
  s_cmp_ge_u32 s2, 256
  s_cbranch_scc1 K1_end
  s_load_dwordx16 s[4:19], s[0:1], 0
  s_load_dwordx16 s[20:35], s[0:1], 64
  s_load_dwordx2 s[36:37], s[0:1], 128
  v_and_b32 v1, 63, v0
  v_lshrrev_b32 v2, 6, v0
  s_nop 0
  v_readfirstlane_b32 s56, v2
  v_and_b32 v3, 15, v1
  v_lshrrev_b32 v4, 4, v1
  s_lshr_b32 s57, s2, 3
  s_and_b32 s57, s57, 7
  s_and_b32 s58, s2, 7
  s_lshl_b32 s58, s58, 2
  s_lshr_b32 s59, s2, 6
  s_add_u32 s58, s58, s59
  s_lshl_b32 s73, s57, 19
  s_lshl_b32 s74, s56, 8
  s_add_u32 s74, s74, 0
  v_add_u32 v20, s74, v1
  v_lshrrev_b32 v21, 2, v20
  v_and_b32 v22, 3, v20
  v_bfe_u32 v23, v21, 3, 1
  v_mul_u32_u24 v23, 3, v23
  v_xor_b32 v22, v22, v23
  v_lshlrev_b32 v21, 11, v21
  v_lshl_add_u32 v21, v22, 4, v21
  v_add_u32 v8, s73, v21
  s_lshl_b32 s74, s56, 8
  s_add_u32 s74, s74, 64
  v_add_u32 v20, s74, v1
  v_lshrrev_b32 v21, 2, v20
  v_and_b32 v22, 3, v20
  v_bfe_u32 v23, v21, 3, 1
  v_mul_u32_u24 v23, 3, v23
  v_xor_b32 v22, v22, v23
  v_lshlrev_b32 v21, 11, v21
  v_lshl_add_u32 v21, v22, 4, v21
  v_add_u32 v9, s73, v21
  s_lshl_b32 s74, s56, 8
  s_add_u32 s74, s74, 128
  v_add_u32 v20, s74, v1
  v_lshrrev_b32 v21, 2, v20
  v_and_b32 v22, 3, v20
  v_bfe_u32 v23, v21, 3, 1
  v_mul_u32_u24 v23, 3, v23
  v_xor_b32 v22, v22, v23
  v_lshlrev_b32 v21, 11, v21
  v_lshl_add_u32 v21, v22, 4, v21
  v_add_u32 v10, s73, v21
  s_lshl_b32 s74, s56, 8
  s_add_u32 s74, s74, 192
  v_add_u32 v20, s74, v1
  v_lshrrev_b32 v21, 2, v20
  v_and_b32 v22, 3, v20
  v_bfe_u32 v23, v21, 3, 1
  v_mul_u32_u24 v23, 3, v23
  v_xor_b32 v22, v22, v23
  v_lshlrev_b32 v21, 11, v21
  v_lshl_add_u32 v21, v22, 4, v21
  v_add_u32 v11, s73, v21
  s_mul_i32 s75, s58, 224
  s_and_b32 s76, s56, 1
  s_lshl_b32 s76, s76, 2
  s_lshr_b32 s77, s56, 1
  s_mul_i32 s77, s77, 7168
  s_add_u32 s77, s77, 16384
  s_add_u32 s74, s76, 0
  s_min_u32 s74, s74, 6
  s_lshl_b32 s78, s74, 10
  s_add_u32 s66, s78, s77
  s_lshl_b32 s74, s74, 6
  v_add_u32 v20, s74, v1
  v_mul_u32_u24 v21, 4682, v20
  v_lshrrev_b32 v21, 16, v21
  v_mul_u32_u24 v22, 14, v21
  v_sub_u32 v22, v20, v22
  v_and_b32 v23, 0x13, v21
  v_bfe_u32 v24, v21, 2, 1
  v_lshl_or_b32 v23, v24, 3, v23
  v_bfe_u32 v24, v21, 3, 1
  v_lshl_or_b32 v23, v24, 2, v23
  v_mul_u32_u24 v23, 7168, v23
  v_lshl_add_u32 v23, v22, 4, v23
  v_add_u32 v12, s75, v23
  s_add_u32 s74, s76, 1
  s_min_u32 s74, s74, 6
  s_lshl_b32 s78, s74, 10
  s_add_u32 s67, s78, s77
  s_lshl_b32 s74, s74, 6
  v_add_u32 v20, s74, v1
  v_mul_u32_u24 v21, 4682, v20
  v_lshrrev_b32 v21, 16, v21
  v_mul_u32_u24 v22, 14, v21
  v_sub_u32 v22, v20, v22
  v_and_b32 v23, 0x13, v21
  v_bfe_u32 v24, v21, 2, 1
  v_lshl_or_b32 v23, v24, 3, v23
  v_bfe_u32 v24, v21, 3, 1
  v_lshl_or_b32 v23, v24, 2, v23
  v_mul_u32_u24 v23, 7168, v23
  v_lshl_add_u32 v23, v22, 4, v23
  v_add_u32 v13, s75, v23
  s_add_u32 s74, s76, 2
  s_min_u32 s74, s74, 6
  s_lshl_b32 s78, s74, 10
  s_add_u32 s68, s78, s77
  s_lshl_b32 s74, s74, 6
  v_add_u32 v20, s74, v1
  v_mul_u32_u24 v21, 4682, v20
  v_lshrrev_b32 v21, 16, v21
  v_mul_u32_u24 v22, 14, v21
  v_sub_u32 v22, v20, v22
  v_and_b32 v23, 0x13, v21
  v_bfe_u32 v24, v21, 2, 1
  v_lshl_or_b32 v23, v24, 3, v23
  v_bfe_u32 v24, v21, 3, 1
  v_lshl_or_b32 v23, v24, 2, v23
  v_mul_u32_u24 v23, 7168, v23
  v_lshl_add_u32 v23, v22, 4, v23
  v_add_u32 v14, s75, v23
  s_add_u32 s74, s76, 3
  s_min_u32 s74, s74, 6
  s_lshl_b32 s78, s74, 10
  s_add_u32 s69, s78, s77
  s_lshl_b32 s74, s74, 6
  v_add_u32 v20, s74, v1
  v_mul_u32_u24 v21, 4682, v20
  v_lshrrev_b32 v21, 16, v21
  v_mul_u32_u24 v22, 14, v21
  v_sub_u32 v22, v20, v22
  v_and_b32 v23, 0x13, v21
  v_bfe_u32 v24, v21, 2, 1
  v_lshl_or_b32 v23, v24, 3, v23
  v_bfe_u32 v24, v21, 3, 1
  v_lshl_or_b32 v23, v24, 2, v23
  v_mul_u32_u24 v23, 7168, v23
  v_lshl_add_u32 v23, v22, 4, v23
  v_add_u32 v15, s75, v23
  s_lshl_b32 s74, s56, 6
  v_add_u32 v20, s74, v1
  v_lshrrev_b32 v21, 2, v20
  v_and_b32 v22, 3, v20
  v_bfe_u32 v23, v21, 3, 1
  v_mul_u32_u24 v23, 3, v23
  v_xor_b32 v22, v22, v23
  v_and_b32 v21, 31, v21
  v_lshlrev_b32 v21, 11, v21
  v_lshl_add_u32 v21, v22, 4, v21
  s_lshl_b32 s74, s58, 16
  v_add_u32 v16, s74, v21
  s_lshl_b32 s70, s56, 12
  s_lshl_b32 s80, s56, 10
  s_add_u32 s80, s80, 30720
  v_bfe_u32 v20, v1, 3, 1
  v_mul_u32_u24 v20, 3, v20
  v_xor_b32 v20, v20, v4
  v_lshlrev_b32 v20, 4, v20
  v_lshl_add_u32 v20, v3, 6, v20
  v_add_u32 v17, s70, v20
  v_add_u32 v19, 30720, v20
  v_bfe_u32 v20, v1, 5, 1
  v_lshlrev_b32 v20, 4, v20
  v_bfe_u32 v21, v1, 4, 1
  v_lshl_add_u32 v20, v21, 2, v20
  v_bfe_u32 v21, v1, 2, 2
  v_add_u32 v20, v20, v21
  v_mul_u32_u24 v20, 224, v20
  v_and_b32 v21, 3, v1
  v_lshl_add_u32 v20, v21, 3, v20
  v_add_u32 v18, 16384, v20
  s_mov_b32 s62, 0
  s_mov_b32 s63, 0
  s_mov_b32 s64, 0
  s_mov_b32 s65, 0
  s_mov_b32 s71, 0
  s_waitcnt lgkmcnt(0)
  s_mov_b32 s40, s4
  s_mov_b32 s41, s5
  s_mov_b32 s42, 0x400000
  s_mov_b32 s43, 0x00020000
  s_cmp_lt_u32 s56, 2
  s_cselect_b32 s44, s24, s26
  s_cselect_b32 s45, s25, s27
  s_mov_b32 s46, 0x700000
  s_mov_b32 s47, 0x00020000
  s_cselect_b32 s96, s10, s12
  s_cselect_b32 s97, s11, s13
  s_mov_b32 s98, 0x200000
  s_mov_b32 s99, 0x00020000
  s_add_u32 s79, s62, s70
  s_add_u32 m0, s79, 0
  s_nop 0
  buffer_load_dwordx4 v8, s[40:43], s63 offen lds
  s_add_u32 m0, s79, 1024
  s_nop 0
  buffer_load_dwordx4 v9, s[40:43], s63 offen lds
  s_add_u32 m0, s79, 2048
  s_nop 0
  buffer_load_dwordx4 v10, s[40:43], s63 offen lds
  s_add_u32 m0, s79, 3072
  s_nop 0
  buffer_load_dwordx4 v11, s[40:43], s63 offen lds
  s_add_u32 m0, s62, s66
  s_nop 0
  buffer_load_dwordx4 v12, s[44:47], s64 offen lds
  s_add_u32 m0, s62, s67
  s_nop 0
  buffer_load_dwordx4 v13, s[44:47], s64 offen lds
  s_add_u32 m0, s62, s68
  s_nop 0
  buffer_load_dwordx4 v14, s[44:47], s64 offen lds
  s_add_u32 m0, s62, s69
  s_nop 0
  buffer_load_dwordx4 v15, s[44:47], s64 offen lds
  s_add_u32 m0, s62, s80
  s_nop 0
  buffer_load_dwordx4 v16, s[96:99], s63 offen lds
  s_add_u32 s63, s63, 64
  s_add_u32 s64, s64, 229376
  s_add_u32 s65, s65, 1
  s_add_u32 s62, s62, 34816
  s_cmp_ge_u32 s62, 139264
  s_cselect_b32 s62, 0, s62
  s_cmp_ge_u32 s65, 32
  s_cselect_b32 s42, 0, s42
  s_cselect_b32 s46, 0, s46
  s_cselect_b32 s98, 0, s98
  s_mov_b32 s48, s30
  s_mov_b32 s49, s31
  s_mov_b32 s50, 0x800
  s_mov_b32 s51, 0x00020000
  s_lshl_b32 s60, s2, 3
  s_lshl_b32 s61, s56, 1
  s_add_u32 s60, s60, s61
  s_lshl_b32 s61, s60, 11
  v_lshlrev_b32 v5, 5, v1
  buffer_load_dwordx4 v[20:23], v5, s[48:51], 0 offen
  buffer_load_dwordx4 v[24:27], v5, s[48:51], 0 offen offset:16
  buffer_load_dwordx4 v[240:243], v5, s[40:43], s61 offen
  buffer_load_dwordx4 v[244:247], v5, s[40:43], s61 offen offset:16
  buffer_load_dwordx4 v[248:251], v5, s[40:43], s61 offen offset:2048
  buffer_load_dwordx4 v[252:255], v5, s[40:43], s61 offen offset:2064
  s_lshl_b32 s74, s58, 6
  v_lshl_add_u32 v28, v3, 2, s74
  s_mov_b32 s48, s6
  s_mov_b32 s49, s7
  s_mov_b32 s50, 0x800
  s_mov_b32 s51, 0x00020000
  buffer_load_dword v29, v28, s[48:51], 0 offen
  s_mov_b32 s48, s8
  s_mov_b32 s49, s9
  s_mov_b32 s50, 0x800
  s_mov_b32 s51, 0x00020000
  buffer_load_dword v30, v28, s[48:51], 0 offen
  s_mov_b32 s48, s18
  s_mov_b32 s49, s19
  s_mov_b32 s50, 0x800
  s_mov_b32 s51, 0x00020000
  buffer_load_dword v31, v28, s[48:51], 0 offen
  v_mov_b32 v128, 0
  s_add_u32 s79, s62, s70
  s_add_u32 m0, s79, 0
  v_accvgpr_write_b32 a0, 0
  v_mov_b32 v129, 0
  v_accvgpr_write_b32 a1, 0
  v_mov_b32 v130, 0
  buffer_load_dwordx4 v8, s[40:43], s63 offen lds
  v_accvgpr_write_b32 a2, 0
  v_mov_b32 v131, 0
  v_accvgpr_write_b32 a3, 0
  v_mov_b32 v132, 0
  v_accvgpr_write_b32 a4, 0
  s_add_u32 m0, s79, 1024
  v_mov_b32 v133, 0
  v_accvgpr_write_b32 a5, 0
  v_mov_b32 v134, 0
  v_accvgpr_write_b32 a6, 0
  buffer_load_dwordx4 v9, s[40:43], s63 offen lds
  v_mov_b32 v135, 0
  v_accvgpr_write_b32 a7, 0
  v_mov_b32 v136, 0
  v_accvgpr_write_b32 a8, 0
  v_mov_b32 v137, 0
  s_add_u32 m0, s79, 2048
  v_accvgpr_write_b32 a9, 0
  v_mov_b32 v138, 0
  v_accvgpr_write_b32 a10, 0
  v_mov_b32 v139, 0
  buffer_load_dwordx4 v10, s[40:43], s63 offen lds
  v_accvgpr_write_b32 a11, 0
  v_mov_b32 v140, 0
  v_accvgpr_write_b32 a12, 0
  v_mov_b32 v141, 0
  v_accvgpr_write_b32 a13, 0
  s_add_u32 m0, s79, 3072
  v_mov_b32 v142, 0
  v_accvgpr_write_b32 a14, 0
  v_mov_b32 v143, 0
  v_accvgpr_write_b32 a15, 0
  v_mov_b32 v144, 0
  buffer_load_dwordx4 v11, s[40:43], s63 offen lds
  v_accvgpr_write_b32 a16, 0
  v_mov_b32 v145, 0
  v_accvgpr_write_b32 a17, 0
  v_mov_b32 v146, 0
  s_add_u32 m0, s62, s66
  v_accvgpr_write_b32 a18, 0
  v_mov_b32 v147, 0
  v_accvgpr_write_b32 a19, 0
  v_mov_b32 v148, 0
  v_accvgpr_write_b32 a20, 0
  buffer_load_dwordx4 v12, s[44:47], s64 offen lds
  v_mov_b32 v149, 0
  v_accvgpr_write_b32 a21, 0
  v_mov_b32 v150, 0
  v_accvgpr_write_b32 a22, 0
  s_add_u32 m0, s62, s67
  v_mov_b32 v151, 0
  v_accvgpr_write_b32 a23, 0
  v_mov_b32 v152, 0
  v_accvgpr_write_b32 a24, 0
  v_mov_b32 v153, 0
  buffer_load_dwordx4 v13, s[44:47], s64 offen lds
  v_accvgpr_write_b32 a25, 0
  v_mov_b32 v154, 0
  v_accvgpr_write_b32 a26, 0
  v_mov_b32 v155, 0
  s_add_u32 m0, s62, s68
  v_accvgpr_write_b32 a27, 0
  v_mov_b32 v156, 0
  v_accvgpr_write_b32 a28, 0
  v_mov_b32 v157, 0
  v_accvgpr_write_b32 a29, 0
  buffer_load_dwordx4 v14, s[44:47], s64 offen lds
  v_mov_b32 v158, 0
  v_accvgpr_write_b32 a30, 0
  v_mov_b32 v159, 0
  v_accvgpr_write_b32 a31, 0
  v_mov_b32 v160, 0
  s_add_u32 m0, s62, s69
  v_accvgpr_write_b32 a32, 0
  v_mov_b32 v161, 0
  v_accvgpr_write_b32 a33, 0
  v_mov_b32 v162, 0
  buffer_load_dwordx4 v15, s[44:47], s64 offen lds
  v_accvgpr_write_b32 a34, 0
  v_mov_b32 v163, 0
  v_accvgpr_write_b32 a35, 0
  v_mov_b32 v164, 0
  v_accvgpr_write_b32 a36, 0
  s_add_u32 m0, s62, s80
  v_mov_b32 v165, 0
  v_accvgpr_write_b32 a37, 0
  v_mov_b32 v166, 0
  v_accvgpr_write_b32 a38, 0
  buffer_load_dwordx4 v16, s[96:99], s63 offen lds
  v_mov_b32 v167, 0
  v_accvgpr_write_b32 a39, 0
  v_mov_b32 v168, 0
  v_accvgpr_write_b32 a40, 0
  v_mov_b32 v169, 0
  s_add_u32 s63, s63, 64
  s_add_u32 s64, s64, 229376
  s_add_u32 s65, s65, 1
  v_accvgpr_write_b32 a41, 0
  v_mov_b32 v170, 0
  v_accvgpr_write_b32 a42, 0
  v_mov_b32 v171, 0
  s_add_u32 s62, s62, 34816
  s_cmp_ge_u32 s62, 139264
  s_cselect_b32 s62, 0, s62
  v_accvgpr_write_b32 a43, 0
  v_mov_b32 v172, 0
  v_accvgpr_write_b32 a44, 0
  v_mov_b32 v173, 0
  v_accvgpr_write_b32 a45, 0
  s_cmp_ge_u32 s65, 32
  s_cselect_b32 s42, 0, s42
  s_cselect_b32 s46, 0, s46
  s_cselect_b32 s98, 0, s98
  v_mov_b32 v174, 0
  v_accvgpr_write_b32 a46, 0
  v_mov_b32 v175, 0
  v_accvgpr_write_b32 a47, 0
  v_mov_b32 v176, 0
  s_add_u32 s79, s62, s70
  s_add_u32 m0, s79, 0
  v_accvgpr_write_b32 a48, 0
  v_mov_b32 v177, 0
  v_accvgpr_write_b32 a49, 0
  v_mov_b32 v178, 0
  buffer_load_dwordx4 v8, s[40:43], s63 offen lds
  v_accvgpr_write_b32 a50, 0
  v_mov_b32 v179, 0
  v_accvgpr_write_b32 a51, 0
  v_mov_b32 v180, 0
  v_accvgpr_write_b32 a52, 0
  s_add_u32 m0, s79, 1024
  v_mov_b32 v181, 0
  v_accvgpr_write_b32 a53, 0
  v_mov_b32 v182, 0
  v_accvgpr_write_b32 a54, 0
  buffer_load_dwordx4 v9, s[40:43], s63 offen lds
  v_mov_b32 v183, 0
  v_accvgpr_write_b32 a55, 0
  v_mov_b32 v184, 0
  v_accvgpr_write_b32 a56, 0
  v_mov_b32 v185, 0
  s_add_u32 m0, s79, 2048
  v_accvgpr_write_b32 a57, 0
  v_mov_b32 v186, 0
  v_accvgpr_write_b32 a58, 0
  v_mov_b32 v187, 0
  buffer_load_dwordx4 v10, s[40:43], s63 offen lds
  v_accvgpr_write_b32 a59, 0
  v_mov_b32 v188, 0
  v_accvgpr_write_b32 a60, 0
  v_mov_b32 v189, 0
  v_accvgpr_write_b32 a61, 0
  s_add_u32 m0, s79, 3072
  v_mov_b32 v190, 0
  v_accvgpr_write_b32 a62, 0
  v_mov_b32 v191, 0
  v_accvgpr_write_b32 a63, 0
  v_mov_b32 v192, 0
  buffer_load_dwordx4 v11, s[40:43], s63 offen lds
  v_accvgpr_write_b32 a64, 0
  v_mov_b32 v193, 0
  v_accvgpr_write_b32 a65, 0
  v_mov_b32 v194, 0
  s_add_u32 m0, s62, s66
  v_accvgpr_write_b32 a66, 0
  v_mov_b32 v195, 0
  v_accvgpr_write_b32 a67, 0
  v_mov_b32 v196, 0
  v_accvgpr_write_b32 a68, 0
  buffer_load_dwordx4 v12, s[44:47], s64 offen lds
  v_mov_b32 v197, 0
  v_accvgpr_write_b32 a69, 0
  v_mov_b32 v198, 0
  v_accvgpr_write_b32 a70, 0
  s_add_u32 m0, s62, s67
  v_mov_b32 v199, 0
  v_accvgpr_write_b32 a71, 0
  v_mov_b32 v200, 0
  v_accvgpr_write_b32 a72, 0
  v_mov_b32 v201, 0
  buffer_load_dwordx4 v13, s[44:47], s64 offen lds
  v_accvgpr_write_b32 a73, 0
  v_mov_b32 v202, 0
  v_accvgpr_write_b32 a74, 0
  v_mov_b32 v203, 0
  s_add_u32 m0, s62, s68
  v_accvgpr_write_b32 a75, 0
  v_mov_b32 v204, 0
  v_accvgpr_write_b32 a76, 0
  v_mov_b32 v205, 0
  v_accvgpr_write_b32 a77, 0
  buffer_load_dwordx4 v14, s[44:47], s64 offen lds
  v_mov_b32 v206, 0
  v_accvgpr_write_b32 a78, 0
  v_mov_b32 v207, 0
  v_accvgpr_write_b32 a79, 0
  v_mov_b32 v208, 0
  s_add_u32 m0, s62, s69
  v_accvgpr_write_b32 a80, 0
  v_mov_b32 v209, 0
  v_accvgpr_write_b32 a81, 0
  v_mov_b32 v210, 0
  buffer_load_dwordx4 v15, s[44:47], s64 offen lds
  v_accvgpr_write_b32 a82, 0
  v_mov_b32 v211, 0
  v_accvgpr_write_b32 a83, 0
  v_mov_b32 v212, 0
  v_accvgpr_write_b32 a84, 0
  s_add_u32 m0, s62, s80
  v_mov_b32 v213, 0
  v_accvgpr_write_b32 a85, 0
  v_mov_b32 v214, 0
  v_accvgpr_write_b32 a86, 0
  buffer_load_dwordx4 v16, s[96:99], s63 offen lds
  v_mov_b32 v215, 0
  v_accvgpr_write_b32 a87, 0
  v_mov_b32 v216, 0
  v_accvgpr_write_b32 a88, 0
  v_mov_b32 v217, 0
  s_add_u32 s63, s63, 64
  s_add_u32 s64, s64, 229376
  s_add_u32 s65, s65, 1
  v_accvgpr_write_b32 a89, 0
  v_mov_b32 v218, 0
  v_accvgpr_write_b32 a90, 0
  v_mov_b32 v219, 0
  s_add_u32 s62, s62, 34816
  s_cmp_ge_u32 s62, 139264
  s_cselect_b32 s62, 0, s62
  v_accvgpr_write_b32 a91, 0
  v_mov_b32 v220, 0
  v_accvgpr_write_b32 a92, 0
  v_mov_b32 v221, 0
  v_accvgpr_write_b32 a93, 0
  s_cmp_ge_u32 s65, 32
  s_cselect_b32 s42, 0, s42
  s_cselect_b32 s46, 0, s46
  s_cselect_b32 s98, 0, s98
  v_mov_b32 v222, 0
  v_accvgpr_write_b32 a94, 0
  v_mov_b32 v223, 0
  v_accvgpr_write_b32 a95, 0
  v_mov_b32 v224, 0
  s_add_u32 s79, s62, s70
  s_add_u32 m0, s79, 0
  v_accvgpr_write_b32 a96, 0
  v_mov_b32 v225, 0
  v_accvgpr_write_b32 a97, 0
  v_mov_b32 v226, 0
  buffer_load_dwordx4 v8, s[40:43], s63 offen lds
  v_accvgpr_write_b32 a98, 0
  v_mov_b32 v227, 0
  v_accvgpr_write_b32 a99, 0
  v_mov_b32 v228, 0
  v_accvgpr_write_b32 a100, 0
  s_add_u32 m0, s79, 1024
  v_mov_b32 v229, 0
  v_accvgpr_write_b32 a101, 0
  v_mov_b32 v230, 0
  v_accvgpr_write_b32 a102, 0
  buffer_load_dwordx4 v9, s[40:43], s63 offen lds
  v_mov_b32 v231, 0
  v_accvgpr_write_b32 a103, 0
  v_mov_b32 v232, 0
  v_accvgpr_write_b32 a104, 0
  v_mov_b32 v233, 0
  s_add_u32 m0, s79, 2048
  v_accvgpr_write_b32 a105, 0
  v_mov_b32 v234, 0
  v_accvgpr_write_b32 a106, 0
  v_mov_b32 v235, 0
  buffer_load_dwordx4 v10, s[40:43], s63 offen lds
  v_accvgpr_write_b32 a107, 0
  v_mov_b32 v236, 0
  v_accvgpr_write_b32 a108, 0
  v_mov_b32 v237, 0
  v_accvgpr_write_b32 a109, 0
  s_add_u32 m0, s79, 3072
  v_mov_b32 v238, 0
  v_accvgpr_write_b32 a110, 0
  v_mov_b32 v239, 0
  v_accvgpr_write_b32 a111, 0
  v_mov_b32 v64, 0
  buffer_load_dwordx4 v11, s[40:43], s63 offen lds
  v_mov_b32 v65, 0
  v_mov_b32 v66, 0
  v_mov_b32 v67, 0
  v_mov_b32 v68, 0
  s_add_u32 m0, s62, s66
  v_mov_b32 v69, 0
  v_mov_b32 v70, 0
  v_mov_b32 v71, 0
  v_mov_b32 v72, 0
  v_mov_b32 v73, 0
  buffer_load_dwordx4 v12, s[44:47], s64 offen lds
  v_mov_b32 v74, 0
  v_mov_b32 v75, 0
  v_mov_b32 v76, 0
  v_mov_b32 v77, 0
  s_add_u32 m0, s62, s67
  v_mov_b32 v78, 0
  v_mov_b32 v79, 0
  v_mov_b32 v80, 0
  v_mov_b32 v81, 0
  v_mov_b32 v82, 0
  buffer_load_dwordx4 v13, s[44:47], s64 offen lds
  v_mov_b32 v83, 0
  v_mov_b32 v84, 0
  v_mov_b32 v85, 0
  v_mov_b32 v86, 0
  s_add_u32 m0, s62, s68
  v_mov_b32 v87, 0
  v_mov_b32 v88, 0
  v_mov_b32 v89, 0
  v_mov_b32 v90, 0
  v_mov_b32 v91, 0
  buffer_load_dwordx4 v14, s[44:47], s64 offen lds
  v_mov_b32 v92, 0
  v_mov_b32 v93, 0
  v_mov_b32 v94, 0
  v_mov_b32 v95, 0
  v_mov_b32 v96, 0
  s_add_u32 m0, s62, s69
  v_mov_b32 v97, 0
  v_mov_b32 v98, 0
  v_mov_b32 v99, 0
  v_mov_b32 v100, 0
  buffer_load_dwordx4 v15, s[44:47], s64 offen lds
  v_mov_b32 v101, 0
  v_mov_b32 v102, 0
  v_mov_b32 v103, 0
  v_mov_b32 v104, 0
  v_mov_b32 v105, 0
  s_add_u32 m0, s62, s80
  v_mov_b32 v106, 0
  v_mov_b32 v107, 0
  v_mov_b32 v108, 0
  v_mov_b32 v109, 0
  buffer_load_dwordx4 v16, s[96:99], s63 offen lds
  v_mov_b32 v110, 0
  v_mov_b32 v111, 0
  v_mov_b32 v112, 0
  v_mov_b32 v113, 0
  v_mov_b32 v114, 0
  s_add_u32 s63, s63, 64
  s_add_u32 s64, s64, 229376
  s_add_u32 s65, s65, 1
  v_mov_b32 v115, 0
  v_mov_b32 v116, 0
  v_mov_b32 v117, 0
  v_mov_b32 v118, 0
  s_add_u32 s62, s62, 34816
  s_cmp_ge_u32 s62, 139264
  s_cselect_b32 s62, 0, s62
  v_mov_b32 v119, 0
  v_mov_b32 v120, 0
  v_mov_b32 v121, 0
  v_mov_b32 v122, 0
  v_mov_b32 v123, 0
  s_cmp_ge_u32 s65, 32
  s_cselect_b32 s42, 0, s42
  s_cselect_b32 s46, 0, s46
  s_cselect_b32 s98, 0, s98
  v_mov_b32 v124, 0
  v_mov_b32 v125, 0
  v_mov_b32 v126, 0
  v_mov_b32 v127, 0
  s_waitcnt vmcnt(36)
  s_barrier
  ds_read_b128 v[32:35], v17 offset:0
  ds_read_b128 v[36:39], v17 offset:1024
  ds_read_b128 v[40:43], v17 offset:2048
  ds_read_b128 v[44:47], v17 offset:3072
  ds_read_b64_tr_b16 a[112:113], v18 offset:0
  ds_read_b64_tr_b16 a[114:115], v18 offset:1792
  ds_read_b64_tr_b16 a[116:117], v18 offset:32
  ds_read_b64_tr_b16 a[118:119], v18 offset:1824
  ds_read_b64_tr_b16 a[120:121], v18 offset:64
  ds_read_b64_tr_b16 a[122:123], v18 offset:1856
  ds_read_b64_tr_b16 a[124:125], v18 offset:96
  ds_read_b64_tr_b16 a[126:127], v18 offset:1888
  ds_read_b64_tr_b16 a[128:129], v18 offset:128
  ds_read_b64_tr_b16 a[130:131], v18 offset:1920
  ds_read_b64_tr_b16 a[132:133], v18 offset:160
  ds_read_b64_tr_b16 a[134:135], v18 offset:1952
  ds_read_b64_tr_b16 a[136:137], v18 offset:192
  ds_read_b64_tr_b16 a[138:139], v18 offset:1984
  ds_read_b64_tr_b16 a[140:141], v18 offset:7168
  ds_read_b64_tr_b16 a[142:143], v18 offset:8960
  ds_read_b64_tr_b16 a[144:145], v18 offset:7200
  ds_read_b64_tr_b16 a[146:147], v18 offset:8992
  ds_read_b64_tr_b16 a[148:149], v18 offset:7232
  ds_read_b64_tr_b16 a[150:151], v18 offset:9024
  ds_read_b64_tr_b16 a[152:153], v18 offset:7264
  ds_read_b64_tr_b16 a[154:155], v18 offset:9056
  ds_read_b64_tr_b16 a[156:157], v18 offset:7296
  ds_read_b64_tr_b16 a[158:159], v18 offset:9088
  ds_read_b64_tr_b16 a[160:161], v18 offset:7328
  ds_read_b64_tr_b16 a[162:163], v18 offset:9120
  ds_read_b64_tr_b16 a[164:165], v18 offset:7360
  ds_read_b64_tr_b16 a[166:167], v18 offset:9152
  ds_read_b128 a[168:171], v19 offset:0
  ds_read_b128 a[172:175], v19 offset:1024
  ds_read_b128 a[176:179], v19 offset:2048
  ds_read_b128 a[180:183], v19 offset:3072
  s_mov_b32 s84, 0
K1_main_1:
  s_waitcnt vmcnt(18) lgkmcnt(0)
  s_barrier
  v_mfma_f32_16x16x32_bf16 v[128:131], a[112:115], v[32:35], v[128:131]
  s_add_u32 s71, s71, 1
  s_cmp_ge_u32 s71, 4
  s_mov_b32 s72, 34816
  s_cselect_b32 s72, 4294862848, s72
  s_cselect_b32 s71, 0, s71
  v_mfma_f32_16x16x32_bf16 v[132:135], a[112:115], v[36:39], v[132:135]
  v_add_u32 v17, s72, v17
  v_mfma_f32_16x16x32_bf16 v[136:139], a[112:115], v[40:43], v[136:139]
  v_add_u32 v18, s72, v18
  v_mfma_f32_16x16x32_bf16 v[140:143], a[112:115], v[44:47], v[140:143]
  v_add_u32 v19, s72, v19
  v_mfma_f32_16x16x32_bf16 v[144:147], a[116:119], v[32:35], v[144:147]
  ds_read_b128 v[48:51], v17 offset:0
  v_mfma_f32_16x16x32_bf16 v[148:151], a[116:119], v[36:39], v[148:151]
  ds_read_b128 v[52:55], v17 offset:1024
  v_mfma_f32_16x16x32_bf16 v[152:155], a[116:119], v[40:43], v[152:155]
  ds_read_b128 v[56:59], v17 offset:2048
  v_mfma_f32_16x16x32_bf16 v[156:159], a[116:119], v[44:47], v[156:159]
  s_add_u32 s79, s62, s70
  s_add_u32 m0, s79, 0
  v_mfma_f32_16x16x32_bf16 v[160:163], a[120:123], v[32:35], v[160:163]
  buffer_load_dwordx4 v8, s[40:43], s63 offen lds
  v_mfma_f32_16x16x32_bf16 v[164:167], a[120:123], v[36:39], v[164:167]
  v_mfma_f32_16x16x32_bf16 v[168:171], a[120:123], v[40:43], v[168:171]
  ds_read_b128 v[60:63], v17 offset:3072
  v_mfma_f32_16x16x32_bf16 v[172:175], a[120:123], v[44:47], v[172:175]
  ds_read_b64_tr_b16 a[184:185], v18 offset:0
  v_mfma_f32_16x16x32_bf16 v[176:179], a[124:127], v[32:35], v[176:179]
  ds_read_b64_tr_b16 a[186:187], v18 offset:1792
  v_mfma_f32_16x16x32_bf16 v[180:183], a[124:127], v[36:39], v[180:183]
  s_add_u32 m0, s79, 1024
  v_mfma_f32_16x16x32_bf16 v[184:187], a[124:127], v[40:43], v[184:187]
  buffer_load_dwordx4 v9, s[40:43], s63 offen lds
  v_mfma_f32_16x16x32_bf16 v[188:191], a[124:127], v[44:47], v[188:191]
  ds_read_b64_tr_b16 a[188:189], v18 offset:32
  v_mfma_f32_16x16x32_bf16 v[192:195], a[128:131], v[32:35], v[192:195]
  ds_read_b64_tr_b16 a[190:191], v18 offset:1824
  v_mfma_f32_16x16x32_bf16 v[196:199], a[128:131], v[36:39], v[196:199]
  ds_read_b64_tr_b16 a[192:193], v18 offset:64
  v_mfma_f32_16x16x32_bf16 v[200:203], a[128:131], v[40:43], v[200:203]
  s_add_u32 m0, s79, 2048
  v_mfma_f32_16x16x32_bf16 v[204:207], a[128:131], v[44:47], v[204:207]
  v_mfma_f32_16x16x32_bf16 v[208:211], a[132:135], v[32:35], v[208:211]
  buffer_load_dwordx4 v10, s[40:43], s63 offen lds
  v_mfma_f32_16x16x32_bf16 v[212:215], a[132:135], v[36:39], v[212:215]
  ds_read_b64_tr_b16 a[194:195], v18 offset:1856
  v_mfma_f32_16x16x32_bf16 v[216:219], a[132:135], v[40:43], v[216:219]
  ds_read_b64_tr_b16 a[196:197], v18 offset:96
  v_mfma_f32_16x16x32_bf16 v[220:223], a[132:135], v[44:47], v[220:223]
  ds_read_b64_tr_b16 a[198:199], v18 offset:1888
  v_mfma_f32_16x16x32_bf16 v[224:227], a[136:139], v[32:35], v[224:227]
  s_add_u32 m0, s79, 3072
  v_mfma_f32_16x16x32_bf16 v[228:231], a[136:139], v[36:39], v[228:231]
  buffer_load_dwordx4 v11, s[40:43], s63 offen lds
  v_mfma_f32_16x16x32_bf16 v[232:235], a[136:139], v[40:43], v[232:235]
  ds_read_b64_tr_b16 a[200:201], v18 offset:128
  v_mfma_f32_16x16x32_bf16 v[236:239], a[136:139], v[44:47], v[236:239]
  ds_read_b64_tr_b16 a[202:203], v18 offset:1920
  v_mfma_f32_16x16x32_bf16 a[0:3], a[140:143], v[32:35], a[0:3]
  ds_read_b64_tr_b16 a[204:205], v18 offset:160
  v_mfma_f32_16x16x32_bf16 a[4:7], a[140:143], v[36:39], a[4:7]
  v_mfma_f32_16x16x32_bf16 a[8:11], a[140:143], v[40:43], a[8:11]
  s_add_u32 m0, s62, s66
  v_mfma_f32_16x16x32_bf16 a[12:15], a[140:143], v[44:47], a[12:15]
  buffer_load_dwordx4 v12, s[44:47], s64 offen lds
  v_mfma_f32_16x16x32_bf16 a[16:19], a[144:147], v[32:35], a[16:19]
  ds_read_b64_tr_b16 a[206:207], v18 offset:1952
  v_mfma_f32_16x16x32_bf16 a[20:23], a[144:147], v[36:39], a[20:23]
  ds_read_b64_tr_b16 a[208:209], v18 offset:192
  v_mfma_f32_16x16x32_bf16 a[24:27], a[144:147], v[40:43], a[24:27]
  ds_read_b64_tr_b16 a[210:211], v18 offset:1984
  v_mfma_f32_16x16x32_bf16 a[28:31], a[144:147], v[44:47], a[28:31]
  s_add_u32 m0, s62, s67
  v_mfma_f32_16x16x32_bf16 a[32:35], a[148:151], v[32:35], a[32:35]
  buffer_load_dwordx4 v13, s[44:47], s64 offen lds
  v_mfma_f32_16x16x32_bf16 a[36:39], a[148:151], v[36:39], a[36:39]
  ds_read_b64_tr_b16 a[212:213], v18 offset:7168
  v_mfma_f32_16x16x32_bf16 a[40:43], a[148:151], v[40:43], a[40:43]
  v_mfma_f32_16x16x32_bf16 a[44:47], a[148:151], v[44:47], a[44:47]
  ds_read_b64_tr_b16 a[214:215], v18 offset:8960
  v_mfma_f32_16x16x32_bf16 a[48:51], a[152:155], v[32:35], a[48:51]
  ds_read_b64_tr_b16 a[216:217], v18 offset:7200
  v_mfma_f32_16x16x32_bf16 a[52:55], a[152:155], v[36:39], a[52:55]
  s_add_u32 m0, s62, s68
  v_mfma_f32_16x16x32_bf16 a[56:59], a[152:155], v[40:43], a[56:59]
  buffer_load_dwordx4 v14, s[44:47], s64 offen lds
  v_mfma_f32_16x16x32_bf16 a[60:63], a[152:155], v[44:47], a[60:63]
  ds_read_b64_tr_b16 a[218:219], v18 offset:8992
  v_mfma_f32_16x16x32_bf16 a[64:67], a[156:159], v[32:35], a[64:67]
  ds_read_b64_tr_b16 a[220:221], v18 offset:7232
  v_mfma_f32_16x16x32_bf16 a[68:71], a[156:159], v[36:39], a[68:71]
  ds_read_b64_tr_b16 a[222:223], v18 offset:9024
  v_mfma_f32_16x16x32_bf16 a[72:75], a[156:159], v[40:43], a[72:75]
  s_add_u32 m0, s62, s69
  v_mfma_f32_16x16x32_bf16 a[76:79], a[156:159], v[44:47], a[76:79]
  buffer_load_dwordx4 v15, s[44:47], s64 offen lds
  v_mfma_f32_16x16x32_bf16 a[80:83], a[160:163], v[32:35], a[80:83]
  v_mfma_f32_16x16x32_bf16 a[84:87], a[160:163], v[36:39], a[84:87]
  ds_read_b64_tr_b16 a[224:225], v18 offset:7264
  v_mfma_f32_16x16x32_bf16 a[88:91], a[160:163], v[40:43], a[88:91]
  ds_read_b64_tr_b16 a[226:227], v18 offset:9056
  v_mfma_f32_16x16x32_bf16 a[92:95], a[160:163], v[44:47], a[92:95]
  ds_read_b64_tr_b16 a[228:229], v18 offset:7296
  v_mfma_f32_16x16x32_bf16 a[96:99], a[164:167], v[32:35], a[96:99]
  s_add_u32 m0, s62, s80
  v_mfma_f32_16x16x32_bf16 a[100:103], a[164:167], v[36:39], a[100:103]
  buffer_load_dwordx4 v16, s[96:99], s63 offen lds
  v_mfma_f32_16x16x32_bf16 a[104:107], a[164:167], v[40:43], a[104:107]
  ds_read_b64_tr_b16 a[230:231], v18 offset:9088
  v_mfma_f32_16x16x32_bf16 a[108:111], a[164:167], v[44:47], a[108:111]
  ds_read_b64_tr_b16 a[232:233], v18 offset:7328
  v_mfma_f32_16x16x32_bf16 v[64:67], a[168:171], v[32:35], v[64:67]
  ds_read_b64_tr_b16 a[234:235], v18 offset:9120
  v_mfma_f32_16x16x32_bf16 v[68:71], a[168:171], v[36:39], v[68:71]
  s_add_u32 s63, s63, 64
  s_add_u32 s64, s64, 229376
  s_add_u32 s65, s65, 1
  v_mfma_f32_16x16x32_bf16 v[72:75], a[168:171], v[40:43], v[72:75]
  v_mfma_f32_16x16x32_bf16 v[76:79], a[168:171], v[44:47], v[76:79]
  ds_read_b64_tr_b16 a[236:237], v18 offset:7360
  v_mfma_f32_16x16x32_bf16 v[80:83], a[172:175], v[32:35], v[80:83]
  ds_read_b64_tr_b16 a[238:239], v18 offset:9152
  v_mfma_f32_16x16x32_bf16 v[84:87], a[172:175], v[36:39], v[84:87]
  ds_read_b128 a[240:243], v19 offset:0
  v_mfma_f32_16x16x32_bf16 v[88:91], a[172:175], v[40:43], v[88:91]
  s_add_u32 s62, s62, 34816
  s_cmp_ge_u32 s62, 139264
  s_cselect_b32 s62, 0, s62
  v_mfma_f32_16x16x32_bf16 v[92:95], a[172:175], v[44:47], v[92:95]
  ds_read_b128 a[244:247], v19 offset:1024
  v_mfma_f32_16x16x32_bf16 v[96:99], a[176:179], v[32:35], v[96:99]
  ds_read_b128 a[248:251], v19 offset:2048
  v_mfma_f32_16x16x32_bf16 v[100:103], a[176:179], v[36:39], v[100:103]
  ds_read_b128 a[252:255], v19 offset:3072
  v_mfma_f32_16x16x32_bf16 v[104:107], a[176:179], v[40:43], v[104:107]
  s_cmp_ge_u32 s65, 32
  s_cselect_b32 s42, 0, s42
  s_cselect_b32 s46, 0, s46
  s_cselect_b32 s98, 0, s98
  v_mfma_f32_16x16x32_bf16 v[108:111], a[176:179], v[44:47], v[108:111]
  v_mfma_f32_16x16x32_bf16 v[112:115], a[180:183], v[32:35], v[112:115]
  v_mfma_f32_16x16x32_bf16 v[116:119], a[180:183], v[36:39], v[116:119]
  v_mfma_f32_16x16x32_bf16 v[120:123], a[180:183], v[40:43], v[120:123]
  v_mfma_f32_16x16x32_bf16 v[124:127], a[180:183], v[44:47], v[124:127]
  s_waitcnt vmcnt(18) lgkmcnt(0)
  s_barrier
  v_mfma_f32_16x16x32_bf16 v[128:131], a[184:187], v[48:51], v[128:131]
  s_add_u32 s71, s71, 1
  s_cmp_ge_u32 s71, 4
  s_mov_b32 s72, 34816
  s_cselect_b32 s72, 4294862848, s72
  s_cselect_b32 s71, 0, s71
  v_mfma_f32_16x16x32_bf16 v[132:135], a[184:187], v[52:55], v[132:135]
  v_add_u32 v17, s72, v17
  v_mfma_f32_16x16x32_bf16 v[136:139], a[184:187], v[56:59], v[136:139]
  v_add_u32 v18, s72, v18
  v_mfma_f32_16x16x32_bf16 v[140:143], a[184:187], v[60:63], v[140:143]
  v_add_u32 v19, s72, v19
  v_mfma_f32_16x16x32_bf16 v[144:147], a[188:191], v[48:51], v[144:147]
  ds_read_b128 v[32:35], v17 offset:0
  v_mfma_f32_16x16x32_bf16 v[148:151], a[188:191], v[52:55], v[148:151]
  ds_read_b128 v[36:39], v17 offset:1024
  v_mfma_f32_16x16x32_bf16 v[152:155], a[188:191], v[56:59], v[152:155]
  ds_read_b128 v[40:43], v17 offset:2048
  v_mfma_f32_16x16x32_bf16 v[156:159], a[188:191], v[60:63], v[156:159]
  s_add_u32 s79, s62, s70
  s_add_u32 m0, s79, 0
  v_mfma_f32_16x16x32_bf16 v[160:163], a[192:195], v[48:51], v[160:163]
  buffer_load_dwordx4 v8, s[40:43], s63 offen lds
  v_mfma_f32_16x16x32_bf16 v[164:167], a[192:195], v[52:55], v[164:167]
  v_mfma_f32_16x16x32_bf16 v[168:171], a[192:195], v[56:59], v[168:171]
  ds_read_b128 v[44:47], v17 offset:3072
  v_mfma_f32_16x16x32_bf16 v[172:175], a[192:195], v[60:63], v[172:175]
  ds_read_b64_tr_b16 a[112:113], v18 offset:0
  v_mfma_f32_16x16x32_bf16 v[176:179], a[196:199], v[48:51], v[176:179]
  ds_read_b64_tr_b16 a[114:115], v18 offset:1792
  v_mfma_f32_16x16x32_bf16 v[180:183], a[196:199], v[52:55], v[180:183]
  s_add_u32 m0, s79, 1024
  v_mfma_f32_16x16x32_bf16 v[184:187], a[196:199], v[56:59], v[184:187]
  buffer_load_dwordx4 v9, s[40:43], s63 offen lds
  v_mfma_f32_16x16x32_bf16 v[188:191], a[196:199], v[60:63], v[188:191]
  ds_read_b64_tr_b16 a[116:117], v18 offset:32
  v_mfma_f32_16x16x32_bf16 v[192:195], a[200:203], v[48:51], v[192:195]
  ds_read_b64_tr_b16 a[118:119], v18 offset:1824
  v_mfma_f32_16x16x32_bf16 v[196:199], a[200:203], v[52:55], v[196:199]
  ds_read_b64_tr_b16 a[120:121], v18 offset:64
  v_mfma_f32_16x16x32_bf16 v[200:203], a[200:203], v[56:59], v[200:203]
  s_add_u32 m0, s79, 2048
  v_mfma_f32_16x16x32_bf16 v[204:207], a[200:203], v[60:63], v[204:207]
  v_mfma_f32_16x16x32_bf16 v[208:211], a[204:207], v[48:51], v[208:211]
  buffer_load_dwordx4 v10, s[40:43], s63 offen lds
  v_mfma_f32_16x16x32_bf16 v[212:215], a[204:207], v[52:55], v[212:215]
  ds_read_b64_tr_b16 a[122:123], v18 offset:1856
  v_mfma_f32_16x16x32_bf16 v[216:219], a[204:207], v[56:59], v[216:219]
  ds_read_b64_tr_b16 a[124:125], v18 offset:96
  v_mfma_f32_16x16x32_bf16 v[220:223], a[204:207], v[60:63], v[220:223]
  ds_read_b64_tr_b16 a[126:127], v18 offset:1888
  v_mfma_f32_16x16x32_bf16 v[224:227], a[208:211], v[48:51], v[224:227]
  s_add_u32 m0, s79, 3072
  v_mfma_f32_16x16x32_bf16 v[228:231], a[208:211], v[52:55], v[228:231]
  buffer_load_dwordx4 v11, s[40:43], s63 offen lds
  v_mfma_f32_16x16x32_bf16 v[232:235], a[208:211], v[56:59], v[232:235]
  ds_read_b64_tr_b16 a[128:129], v18 offset:128
  v_mfma_f32_16x16x32_bf16 v[236:239], a[208:211], v[60:63], v[236:239]
  ds_read_b64_tr_b16 a[130:131], v18 offset:1920
  v_mfma_f32_16x16x32_bf16 a[0:3], a[212:215], v[48:51], a[0:3]
  ds_read_b64_tr_b16 a[132:133], v18 offset:160
  v_mfma_f32_16x16x32_bf16 a[4:7], a[212:215], v[52:55], a[4:7]
  v_mfma_f32_16x16x32_bf16 a[8:11], a[212:215], v[56:59], a[8:11]
  s_add_u32 m0, s62, s66
  v_mfma_f32_16x16x32_bf16 a[12:15], a[212:215], v[60:63], a[12:15]
  buffer_load_dwordx4 v12, s[44:47], s64 offen lds
  v_mfma_f32_16x16x32_bf16 a[16:19], a[216:219], v[48:51], a[16:19]
  ds_read_b64_tr_b16 a[134:135], v18 offset:1952
  v_mfma_f32_16x16x32_bf16 a[20:23], a[216:219], v[52:55], a[20:23]
  ds_read_b64_tr_b16 a[136:137], v18 offset:192
  v_mfma_f32_16x16x32_bf16 a[24:27], a[216:219], v[56:59], a[24:27]
  ds_read_b64_tr_b16 a[138:139], v18 offset:1984
  v_mfma_f32_16x16x32_bf16 a[28:31], a[216:219], v[60:63], a[28:31]
  s_add_u32 m0, s62, s67
  v_mfma_f32_16x16x32_bf16 a[32:35], a[220:223], v[48:51], a[32:35]
  buffer_load_dwordx4 v13, s[44:47], s64 offen lds
  v_mfma_f32_16x16x32_bf16 a[36:39], a[220:223], v[52:55], a[36:39]
  ds_read_b64_tr_b16 a[140:141], v18 offset:7168
  v_mfma_f32_16x16x32_bf16 a[40:43], a[220:223], v[56:59], a[40:43]
  v_mfma_f32_16x16x32_bf16 a[44:47], a[220:223], v[60:63], a[44:47]
  ds_read_b64_tr_b16 a[142:143], v18 offset:8960
  v_mfma_f32_16x16x32_bf16 a[48:51], a[224:227], v[48:51], a[48:51]
  ds_read_b64_tr_b16 a[144:145], v18 offset:7200
  v_mfma_f32_16x16x32_bf16 a[52:55], a[224:227], v[52:55], a[52:55]
  s_add_u32 m0, s62, s68
  v_mfma_f32_16x16x32_bf16 a[56:59], a[224:227], v[56:59], a[56:59]
  buffer_load_dwordx4 v14, s[44:47], s64 offen lds
  v_mfma_f32_16x16x32_bf16 a[60:63], a[224:227], v[60:63], a[60:63]
  ds_read_b64_tr_b16 a[146:147], v18 offset:8992
  v_mfma_f32_16x16x32_bf16 a[64:67], a[228:231], v[48:51], a[64:67]
  ds_read_b64_tr_b16 a[148:149], v18 offset:7232
  v_mfma_f32_16x16x32_bf16 a[68:71], a[228:231], v[52:55], a[68:71]
  ds_read_b64_tr_b16 a[150:151], v18 offset:9024
  v_mfma_f32_16x16x32_bf16 a[72:75], a[228:231], v[56:59], a[72:75]
  s_add_u32 m0, s62, s69
  v_mfma_f32_16x16x32_bf16 a[76:79], a[228:231], v[60:63], a[76:79]
  buffer_load_dwordx4 v15, s[44:47], s64 offen lds
  v_mfma_f32_16x16x32_bf16 a[80:83], a[232:235], v[48:51], a[80:83]
  v_mfma_f32_16x16x32_bf16 a[84:87], a[232:235], v[52:55], a[84:87]
  ds_read_b64_tr_b16 a[152:153], v18 offset:7264
  v_mfma_f32_16x16x32_bf16 a[88:91], a[232:235], v[56:59], a[88:91]
  ds_read_b64_tr_b16 a[154:155], v18 offset:9056
  v_mfma_f32_16x16x32_bf16 a[92:95], a[232:235], v[60:63], a[92:95]
  ds_read_b64_tr_b16 a[156:157], v18 offset:7296
  v_mfma_f32_16x16x32_bf16 a[96:99], a[236:239], v[48:51], a[96:99]
  s_add_u32 m0, s62, s80
  v_mfma_f32_16x16x32_bf16 a[100:103], a[236:239], v[52:55], a[100:103]
  buffer_load_dwordx4 v16, s[96:99], s63 offen lds
  v_mfma_f32_16x16x32_bf16 a[104:107], a[236:239], v[56:59], a[104:107]
  ds_read_b64_tr_b16 a[158:159], v18 offset:9088
  v_mfma_f32_16x16x32_bf16 a[108:111], a[236:239], v[60:63], a[108:111]
  ds_read_b64_tr_b16 a[160:161], v18 offset:7328
  v_mfma_f32_16x16x32_bf16 v[64:67], a[240:243], v[48:51], v[64:67]
  ds_read_b64_tr_b16 a[162:163], v18 offset:9120
  v_mfma_f32_16x16x32_bf16 v[68:71], a[240:243], v[52:55], v[68:71]
  s_add_u32 s63, s63, 64
  s_add_u32 s64, s64, 229376
  s_add_u32 s65, s65, 1
  v_mfma_f32_16x16x32_bf16 v[72:75], a[240:243], v[56:59], v[72:75]
  v_mfma_f32_16x16x32_bf16 v[76:79], a[240:243], v[60:63], v[76:79]
  ds_read_b64_tr_b16 a[164:165], v18 offset:7360
  v_mfma_f32_16x16x32_bf16 v[80:83], a[244:247], v[48:51], v[80:83]
  ds_read_b64_tr_b16 a[166:167], v18 offset:9152
  v_mfma_f32_16x16x32_bf16 v[84:87], a[244:247], v[52:55], v[84:87]
  ds_read_b128 a[168:171], v19 offset:0
  v_mfma_f32_16x16x32_bf16 v[88:91], a[244:247], v[56:59], v[88:91]
  s_add_u32 s62, s62, 34816
  s_cmp_ge_u32 s62, 139264
  s_cselect_b32 s62, 0, s62
  v_mfma_f32_16x16x32_bf16 v[92:95], a[244:247], v[60:63], v[92:95]
  ds_read_b128 a[172:175], v19 offset:1024
  v_mfma_f32_16x16x32_bf16 v[96:99], a[248:251], v[48:51], v[96:99]
  ds_read_b128 a[176:179], v19 offset:2048
  v_mfma_f32_16x16x32_bf16 v[100:103], a[248:251], v[52:55], v[100:103]
  ds_read_b128 a[180:183], v19 offset:3072
  v_mfma_f32_16x16x32_bf16 v[104:107], a[248:251], v[56:59], v[104:107]
  s_cmp_ge_u32 s65, 32
  s_cselect_b32 s42, 0, s42
  s_cselect_b32 s46, 0, s46
  s_cselect_b32 s98, 0, s98
  v_mfma_f32_16x16x32_bf16 v[108:111], a[248:251], v[60:63], v[108:111]
  v_mfma_f32_16x16x32_bf16 v[112:115], a[252:255], v[48:51], v[112:115]
  v_mfma_f32_16x16x32_bf16 v[116:119], a[252:255], v[52:55], v[116:119]
  v_mfma_f32_16x16x32_bf16 v[120:123], a[252:255], v[56:59], v[120:123]
  v_mfma_f32_16x16x32_bf16 v[124:127], a[252:255], v[60:63], v[124:127]
  s_add_u32 s84, s84, 1
  s_cmp_lt_u32 s84, 16
  s_cbranch_scc1 K1_main_1
  s_waitcnt vmcnt(0) lgkmcnt(0)
  s_barrier
  v_mov_b32 v36, v29
  v_mov_b32 v37, v30
  v_mov_b32 v38, v31
  v_mov_b32 v28, 0
  v_lshlrev_b32 v32, 16, v240
  v_lshlrev_b32 v33, 16, v20
  v_and_b32 v34, 0xffff0000, v240
  v_and_b32 v35, 0xffff0000, v20
  v_mul_f32 v32, v32, v33
  v_mul_f32 v34, v34, v35
  v_cvt_pk_bf16_f32 v32, v32, v34
  v_lshlrev_b32 v33, 16, v32
  v_and_b32 v34, 0xffff0000, v32
  v_add_f32 v28, v28, v33
  v_add_f32 v28, v28, v34
  v_lshlrev_b32 v32, 16, v241
  v_lshlrev_b32 v33, 16, v21
  v_and_b32 v34, 0xffff0000, v241
  v_and_b32 v35, 0xffff0000, v21
  v_mul_f32 v32, v32, v33
  v_mul_f32 v34, v34, v35
  v_cvt_pk_bf16_f32 v32, v32, v34
  v_lshlrev_b32 v33, 16, v32
  v_and_b32 v34, 0xffff0000, v32
  v_add_f32 v28, v28, v33
  v_add_f32 v28, v28, v34
  v_lshlrev_b32 v32, 16, v242
  v_lshlrev_b32 v33, 16, v22
  v_and_b32 v34, 0xffff0000, v242
  v_and_b32 v35, 0xffff0000, v22
  v_mul_f32 v32, v32, v33
  v_mul_f32 v34, v34, v35
  v_cvt_pk_bf16_f32 v32, v32, v34
  v_lshlrev_b32 v33, 16, v32
  v_and_b32 v34, 0xffff0000, v32
  v_add_f32 v28, v28, v33
  v_add_f32 v28, v28, v34
  v_lshlrev_b32 v32, 16, v243
  v_lshlrev_b32 v33, 16, v23
  v_and_b32 v34, 0xffff0000, v243
  v_and_b32 v35, 0xffff0000, v23
  v_mul_f32 v32, v32, v33
  v_mul_f32 v34, v34, v35
  v_cvt_pk_bf16_f32 v32, v32, v34
  v_lshlrev_b32 v33, 16, v32
  v_and_b32 v34, 0xffff0000, v32
  v_add_f32 v28, v28, v33
  v_add_f32 v28, v28, v34
  v_lshlrev_b32 v32, 16, v244
  v_lshlrev_b32 v33, 16, v24
  v_and_b32 v34, 0xffff0000, v244
  v_and_b32 v35, 0xffff0000, v24
  v_mul_f32 v32, v32, v33
  v_mul_f32 v34, v34, v35
  v_cvt_pk_bf16_f32 v32, v32, v34
  v_lshlrev_b32 v33, 16, v32
  v_and_b32 v34, 0xffff0000, v32
  v_add_f32 v28, v28, v33
  v_add_f32 v28, v28, v34
  v_lshlrev_b32 v32, 16, v245
  v_lshlrev_b32 v33, 16, v25
  v_and_b32 v34, 0xffff0000, v245
  v_and_b32 v35, 0xffff0000, v25
  v_mul_f32 v32, v32, v33
  v_mul_f32 v34, v34, v35
  v_cvt_pk_bf16_f32 v32, v32, v34
  v_lshlrev_b32 v33, 16, v32
  v_and_b32 v34, 0xffff0000, v32
  v_add_f32 v28, v28, v33
  v_add_f32 v28, v28, v34
  v_lshlrev_b32 v32, 16, v246
  v_lshlrev_b32 v33, 16, v26
  v_and_b32 v34, 0xffff0000, v246
  v_and_b32 v35, 0xffff0000, v26
  v_mul_f32 v32, v32, v33
  v_mul_f32 v34, v34, v35
  v_cvt_pk_bf16_f32 v32, v32, v34
  v_lshlrev_b32 v33, 16, v32
  v_and_b32 v34, 0xffff0000, v32
  v_add_f32 v28, v28, v33
  v_add_f32 v28, v28, v34
  v_lshlrev_b32 v32, 16, v247
  v_lshlrev_b32 v33, 16, v27
  v_and_b32 v34, 0xffff0000, v247
  v_and_b32 v35, 0xffff0000, v27
  v_mul_f32 v32, v32, v33
  v_mul_f32 v34, v34, v35
  v_cvt_pk_bf16_f32 v32, v32, v34
  v_lshlrev_b32 v33, 16, v32
  v_and_b32 v34, 0xffff0000, v32
  v_add_f32 v28, v28, v33
  v_add_f32 v28, v28, v34
  v_mov_b32 v29, 0
  v_lshlrev_b32 v32, 16, v248
  v_lshlrev_b32 v33, 16, v20
  v_and_b32 v34, 0xffff0000, v248
  v_and_b32 v35, 0xffff0000, v20
  v_mul_f32 v32, v32, v33
  v_mul_f32 v34, v34, v35
  v_cvt_pk_bf16_f32 v32, v32, v34
  v_lshlrev_b32 v33, 16, v32
  v_and_b32 v34, 0xffff0000, v32
  v_add_f32 v29, v29, v33
  v_add_f32 v29, v29, v34
  v_lshlrev_b32 v32, 16, v249
  v_lshlrev_b32 v33, 16, v21
  v_and_b32 v34, 0xffff0000, v249
  v_and_b32 v35, 0xffff0000, v21
  v_mul_f32 v32, v32, v33
  v_mul_f32 v34, v34, v35
  v_cvt_pk_bf16_f32 v32, v32, v34
  v_lshlrev_b32 v33, 16, v32
  v_and_b32 v34, 0xffff0000, v32
  v_add_f32 v29, v29, v33
  v_add_f32 v29, v29, v34
  v_lshlrev_b32 v32, 16, v250
  v_lshlrev_b32 v33, 16, v22
  v_and_b32 v34, 0xffff0000, v250
  v_and_b32 v35, 0xffff0000, v22
  v_mul_f32 v32, v32, v33
  v_mul_f32 v34, v34, v35
  v_cvt_pk_bf16_f32 v32, v32, v34
  v_lshlrev_b32 v33, 16, v32
  v_and_b32 v34, 0xffff0000, v32
  v_add_f32 v29, v29, v33
  v_add_f32 v29, v29, v34
  v_lshlrev_b32 v32, 16, v251
  v_lshlrev_b32 v33, 16, v23
  v_and_b32 v34, 0xffff0000, v251
  v_and_b32 v35, 0xffff0000, v23
  v_mul_f32 v32, v32, v33
  v_mul_f32 v34, v34, v35
  v_cvt_pk_bf16_f32 v32, v32, v34
  v_lshlrev_b32 v33, 16, v32
  v_and_b32 v34, 0xffff0000, v32
  v_add_f32 v29, v29, v33
  v_add_f32 v29, v29, v34
  v_lshlrev_b32 v32, 16, v252
  v_lshlrev_b32 v33, 16, v24
  v_and_b32 v34, 0xffff0000, v252
  v_and_b32 v35, 0xffff0000, v24
  v_mul_f32 v32, v32, v33
  v_mul_f32 v34, v34, v35
  v_cvt_pk_bf16_f32 v32, v32, v34
  v_lshlrev_b32 v33, 16, v32
  v_and_b32 v34, 0xffff0000, v32
  v_add_f32 v29, v29, v33
  v_add_f32 v29, v29, v34
  v_lshlrev_b32 v32, 16, v253
  v_lshlrev_b32 v33, 16, v25
  v_and_b32 v34, 0xffff0000, v253
  v_and_b32 v35, 0xffff0000, v25
  v_mul_f32 v32, v32, v33
  v_mul_f32 v34, v34, v35
  v_cvt_pk_bf16_f32 v32, v32, v34
  v_lshlrev_b32 v33, 16, v32
  v_and_b32 v34, 0xffff0000, v32
  v_add_f32 v29, v29, v33
  v_add_f32 v29, v29, v34
  v_lshlrev_b32 v32, 16, v254
  v_lshlrev_b32 v33, 16, v26
  v_and_b32 v34, 0xffff0000, v254
  v_and_b32 v35, 0xffff0000, v26
  v_mul_f32 v32, v32, v33
  v_mul_f32 v34, v34, v35
  v_cvt_pk_bf16_f32 v32, v32, v34
  v_lshlrev_b32 v33, 16, v32
  v_and_b32 v34, 0xffff0000, v32
  v_add_f32 v29, v29, v33
  v_add_f32 v29, v29, v34
  v_lshlrev_b32 v32, 16, v255
  v_lshlrev_b32 v33, 16, v27
  v_and_b32 v34, 0xffff0000, v255
  v_and_b32 v35, 0xffff0000, v27
  v_mul_f32 v32, v32, v33
  v_mul_f32 v34, v34, v35
  v_cvt_pk_bf16_f32 v32, v32, v34
  v_lshlrev_b32 v33, 16, v32
  v_and_b32 v34, 0xffff0000, v32
  v_add_f32 v29, v29, v33
  v_add_f32 v29, v29, v34
  ds_swizzle_b32 v30, v28 offset:0x041F
  ds_swizzle_b32 v31, v29 offset:0x041F
  s_waitcnt lgkmcnt(0)
  v_add_f32 v28, v28, v30
  v_add_f32 v29, v29, v31
  ds_swizzle_b32 v30, v28 offset:0x081F
  ds_swizzle_b32 v31, v29 offset:0x081F
  s_waitcnt lgkmcnt(0)
  v_add_f32 v28, v28, v30
  v_add_f32 v29, v29, v31
  ds_swizzle_b32 v30, v28 offset:0x101F
  ds_swizzle_b32 v31, v29 offset:0x101F
  s_waitcnt lgkmcnt(0)
  v_add_f32 v28, v28, v30
  v_add_f32 v29, v29, v31
  ds_swizzle_b32 v30, v28 offset:0x201F
  ds_swizzle_b32 v31, v29 offset:0x201F
  s_waitcnt lgkmcnt(0)
  v_add_f32 v28, v28, v30
  v_add_f32 v29, v29, v31
  ds_swizzle_b32 v30, v28 offset:0x401F
  ds_swizzle_b32 v31, v29 offset:0x401F
  s_waitcnt lgkmcnt(0)
  v_add_f32 v28, v28, v30
  v_add_f32 v29, v29, v31
  s_nop 1
  v_readlane_b32 s81, v28, 32
  v_readlane_b32 s82, v29, 32
  s_nop 1
  v_add_f32 v28, s81, v28
  v_add_f32 v29, s82, v29
  s_add_u32 s48, s36, 0x2400000
  s_addc_u32 s49, s37, 0
  s_mov_b32 s50, 0x2000
  s_mov_b32 s51, 0x00020000
  v_cvt_pk_bf16_f32 v32, v28, v28
  v_lshlrev_b32 v28, 16, v32
  v_mul_f32 v33, 0xbfb8aa3b, v28
  v_exp_f32 v33, v33
  s_nop 0
  v_add_f32 v33, 1.0, v33
  v_rcp_f32 v33, v33
  s_nop 0
  v_cvt_pk_bf16_f32 v32, v33, v33
  v_lshlrev_b32 v28, 16, v32
  v_cvt_pk_bf16_f32 v32, v29, v29
  v_lshlrev_b32 v29, 16, v32
  v_mul_f32 v33, 0xbfb8aa3b, v29
  v_exp_f32 v33, v33
  s_nop 0
  v_add_f32 v33, 1.0, v33
  v_rcp_f32 v33, v33
  s_nop 0
  v_cvt_pk_bf16_f32 v32, v33, v33
  v_lshlrev_b32 v29, 16, v32
  s_lshl_b32 s61, s60, 2
  v_mov_b32 v33, 0
  s_mov_b64 s[82:83], exec
  s_mov_b64 exec, 1
  buffer_store_dword v28, v33, s[48:51], s61 offen
  buffer_store_dword v29, v33, s[48:51], s61 offen offset:4
  s_mov_b64 exec, s[82:83]
  s_lshl_b32 s74, s56, 6
  v_add_u32 v20, s74, v3
  v_mul_u32_u24 v20, 272, v20
  v_lshl_add_u32 v20, v4, 4, v20
  ds_write_b128 v20, v[64:67] offset:0
  ds_write_b128 v20, v[68:71] offset:4352
  ds_write_b128 v20, v[72:75] offset:8704
  ds_write_b128 v20, v[76:79] offset:13056
  ds_write_b128 v20, v[80:83] offset:64
  ds_write_b128 v20, v[84:87] offset:4416
  ds_write_b128 v20, v[88:91] offset:8768
  ds_write_b128 v20, v[92:95] offset:13120
  ds_write_b128 v20, v[96:99] offset:128
  ds_write_b128 v20, v[100:103] offset:4480
  ds_write_b128 v20, v[104:107] offset:8832
  ds_write_b128 v20, v[108:111] offset:13184
  ds_write_b128 v20, v[112:115] offset:192
  ds_write_b128 v20, v[116:119] offset:4544
  ds_write_b128 v20, v[120:123] offset:8896
  ds_write_b128 v20, v[124:127] offset:13248
  s_lshl_b32 s74, s56, 2
  v_add_u32 v34, s74, v4
  s_lshl_b32 s74, s58, 6
  v_lshl_add_u32 v35, v3, 2, s74
  s_waitcnt lgkmcnt(0)
  s_barrier
  v_lshlrev_b32 v62, 4, v34
  v_mul_u32_u24 v62, 272, v62
  v_lshl_add_u32 v62, v3, 3, v62
  ds_read_b64 v[64:65], v62 offset:0
  ds_read_b64 v[66:67], v62 offset:128
  ds_read_b64 v[68:69], v62 offset:272
  ds_read_b64 v[70:71], v62 offset:400
  ds_read_b64 v[72:73], v62 offset:544
  ds_read_b64 v[74:75], v62 offset:672
  ds_read_b64 v[76:77], v62 offset:816
  ds_read_b64 v[78:79], v62 offset:944
  ds_read_b64 v[80:81], v62 offset:1088
  ds_read_b64 v[82:83], v62 offset:1216
  ds_read_b64 v[84:85], v62 offset:1360
  ds_read_b64 v[86:87], v62 offset:1488
  ds_read_b64 v[88:89], v62 offset:1632
  ds_read_b64 v[90:91], v62 offset:1760
  ds_read_b64 v[92:93], v62 offset:1904
  ds_read_b64 v[94:95], v62 offset:2032
  ds_read_b64 v[96:97], v62 offset:2176
  ds_read_b64 v[98:99], v62 offset:2304
  ds_read_b64 v[100:101], v62 offset:2448
  ds_read_b64 v[102:103], v62 offset:2576
  ds_read_b64 v[104:105], v62 offset:2720
  ds_read_b64 v[106:107], v62 offset:2848
  ds_read_b64 v[108:109], v62 offset:2992
  ds_read_b64 v[110:111], v62 offset:3120
  ds_read_b64 v[112:113], v62 offset:3264
  ds_read_b64 v[114:115], v62 offset:3392
  ds_read_b64 v[116:117], v62 offset:3536
  ds_read_b64 v[118:119], v62 offset:3664
  ds_read_b64 v[120:121], v62 offset:3808
  ds_read_b64 v[122:123], v62 offset:3936
  ds_read_b64 v[124:125], v62 offset:4080
  ds_read_b64 v[126:127], v62 offset:4208
  v_lshlrev_b32 v40, 16, v36
  v_and_b32 v41, 0xffff0000, v36
  v_lshlrev_b32 v42, 16, v37
  v_and_b32 v43, 0xffff0000, v37
  v_lshlrev_b32 v44, 16, v38
  v_and_b32 v45, 0xffff0000, v38
  v_mul_f32 v44, 0x3fb8aa3b, v44
  v_exp_f32 v44, v44
  s_nop 0
  v_cvt_pk_bf16_f32 v32, v44, v44
  v_lshlrev_b32 v44, 16, v32
  v_mul_f32 v46, v44, v40
  v_mul_f32 v47, v44, v42
  v_mul_f32 v46, 0x3fb8aa3b, v46
  v_exp_f32 v46, v46
  v_mul_f32 v47, 0.15915494, v47
  v_fract_f32 v47, v47
  v_cos_f32 v48, v47
  v_sin_f32 v49, v47
  s_nop 0
  v_mul_f32 v50, v46, v48
  v_mul_f32 v52, v46, v49
  v_mul_f32 v46, v40, v40
  v_fmac_f32 v46, v42, v42
  v_rcp_f32 v46, v46
  v_add_f32 v47, -1.0, v50
  v_mul_f32 v48, v47, v40
  v_fmac_f32 v48, v52, v42
  v_mul_f32 v49, v52, v40
  v_fma_f32 v49, -v47, v42, v49
  v_mul_f32 v54, v48, v46
  v_mul_f32 v56, v49, v46
  v_mul_f32 v45, 0x3fb8aa3b, v45
  v_exp_f32 v45, v45
  s_nop 0
  v_cvt_pk_bf16_f32 v32, v45, v45
  v_lshlrev_b32 v45, 16, v32
  v_mul_f32 v46, v45, v41
  v_mul_f32 v47, v45, v43
  v_mul_f32 v46, 0x3fb8aa3b, v46
  v_exp_f32 v46, v46
  v_mul_f32 v47, 0.15915494, v47
  v_fract_f32 v47, v47
  v_cos_f32 v48, v47
  v_sin_f32 v49, v47
  s_nop 0
  v_mul_f32 v51, v46, v48
  v_mul_f32 v53, v46, v49
  v_mul_f32 v46, v41, v41
  v_fmac_f32 v46, v43, v43
  v_rcp_f32 v46, v46
  v_add_f32 v47, -1.0, v51
  v_mul_f32 v48, v47, v41
  v_fmac_f32 v48, v53, v43
  v_mul_f32 v49, v53, v41
  v_fma_f32 v49, -v47, v43, v49
  v_mul_f32 v55, v48, v46
  v_mul_f32 v57, v49, v46
  v_xor_b32 v58, 0x80000000, v52
  v_xor_b32 v60, 0x80000000, v56
  v_xor_b32 v59, 0x80000000, v53
  v_xor_b32 v61, 0x80000000, v57
  v_mov_b32 v8, v50
  v_mov_b32 v10, v52
  v_mov_b32 v9, v51
  v_mov_b32 v11, v53
  v_xor_b32 v12, 0x80000000, v10
  v_xor_b32 v13, 0x80000000, v11
  v_pk_mul_f32 v[20:21], v[8:9], v[8:9]
  v_pk_mul_f32 v[22:23], v[10:11], v[8:9]
  v_pk_fma_f32 v[20:21], v[10:11], v[12:13], v[20:21]
  v_pk_fma_f32 v[22:23], v[8:9], v[10:11], v[22:23]
  v_mov_b32 v8, v20
  v_mov_b32 v9, v21
  v_mov_b32 v10, v22
  v_mov_b32 v11, v23
  v_xor_b32 v12, 0x80000000, v10
  v_xor_b32 v13, 0x80000000, v11
  v_pk_mul_f32 v[20:21], v[8:9], v[8:9]
  v_pk_mul_f32 v[22:23], v[10:11], v[8:9]
  v_pk_fma_f32 v[20:21], v[10:11], v[12:13], v[20:21]
  v_pk_fma_f32 v[22:23], v[8:9], v[10:11], v[22:23]
  v_mov_b32 v8, v20
  v_mov_b32 v9, v21
  v_mov_b32 v10, v22
  v_mov_b32 v11, v23
  v_xor_b32 v12, 0x80000000, v10
  v_xor_b32 v13, 0x80000000, v11
  v_pk_mul_f32 v[20:21], v[8:9], v[8:9]
  v_pk_mul_f32 v[22:23], v[10:11], v[8:9]
  v_pk_fma_f32 v[20:21], v[10:11], v[12:13], v[20:21]
  v_pk_fma_f32 v[22:23], v[8:9], v[10:11], v[22:23]
  v_mov_b32 v8, v20
  v_mov_b32 v9, v21
  v_mov_b32 v10, v22
  v_mov_b32 v11, v23
  v_xor_b32 v12, 0x80000000, v10
  v_xor_b32 v13, 0x80000000, v11
  v_pk_mul_f32 v[20:21], v[8:9], v[8:9]
  v_pk_mul_f32 v[22:23], v[10:11], v[8:9]
  v_pk_fma_f32 v[20:21], v[10:11], v[12:13], v[20:21]
  v_pk_fma_f32 v[22:23], v[8:9], v[10:11], v[22:23]
  v_mov_b32 v8, v20
  v_mov_b32 v9, v21
  v_mov_b32 v10, v22
  v_mov_b32 v11, v23
  v_xor_b32 v12, 0x80000000, v10
  v_xor_b32 v13, 0x80000000, v11
  v_mov_b32 v14, v8
  v_mov_b32 v16, v10
  v_mov_b32 v15, v9
  v_mov_b32 v17, v11
  v_xor_b32 v18, 0x80000000, v16
  v_xor_b32 v19, 0x80000000, v17
  v_pk_mul_f32 v[20:21], v[14:15], v[14:15]
  v_pk_mul_f32 v[22:23], v[16:17], v[14:15]
  v_pk_fma_f32 v[20:21], v[16:17], v[18:19], v[20:21]
  v_pk_fma_f32 v[22:23], v[14:15], v[16:17], v[22:23]
  v_mov_b32 v14, v20
  v_mov_b32 v15, v21
  v_mov_b32 v16, v22
  v_mov_b32 v17, v23
  v_xor_b32 v18, 0x80000000, v16
  v_xor_b32 v19, 0x80000000, v17
  v_pk_mul_f32 v[20:21], v[14:15], v[14:15]
  v_pk_mul_f32 v[22:23], v[16:17], v[14:15]
  v_pk_fma_f32 v[20:21], v[16:17], v[18:19], v[20:21]
  v_pk_fma_f32 v[22:23], v[14:15], v[16:17], v[22:23]
  v_mov_b32 v14, v20
  v_mov_b32 v15, v21
  v_mov_b32 v16, v22
  v_mov_b32 v17, v23
  v_xor_b32 v18, 0x80000000, v16
  v_xor_b32 v19, 0x80000000, v17
  v_pk_mul_f32 v[20:21], v[14:15], v[14:15]
  v_pk_mul_f32 v[22:23], v[16:17], v[14:15]
  v_pk_fma_f32 v[20:21], v[16:17], v[18:19], v[20:21]
  v_pk_fma_f32 v[22:23], v[14:15], v[16:17], v[22:23]
  v_mov_b32 v14, v20
  v_mov_b32 v15, v21
  v_mov_b32 v16, v22
  v_mov_b32 v17, v23
  v_xor_b32 v18, 0x80000000, v16
  v_xor_b32 v19, 0x80000000, v17
  v_pk_mul_f32 v[20:21], v[14:15], v[14:15]
  v_pk_mul_f32 v[22:23], v[16:17], v[14:15]
  v_pk_fma_f32 v[20:21], v[16:17], v[18:19], v[20:21]
  v_pk_fma_f32 v[22:23], v[14:15], v[16:17], v[22:23]
  v_mov_b32 v14, v20
  v_mov_b32 v15, v21
  v_mov_b32 v16, v22
  v_mov_b32 v17, v23
  v_xor_b32 v18, 0x80000000, v16
  v_xor_b32 v19, 0x80000000, v17
  s_waitcnt lgkmcnt(0)
  v_mov_b32 v24, 0
  v_mov_b32 v25, 0
  v_mov_b32 v26, 0
  v_mov_b32 v27, 0
  v_pk_mul_f32 v[28:29], v[64:65], v[54:55]
  v_pk_mul_f32 v[30:31], v[66:67], v[54:55]
  v_pk_fma_f32 v[28:29], v[66:67], v[60:61], v[28:29]
  v_pk_fma_f32 v[66:67], v[64:65], v[56:57], v[30:31]
  v_mov_b32 v64, v28
  v_mov_b32 v65, v29
  ds_write_b64 v62, v[64:65] offset:0
  ds_write_b64 v62, v[66:67] offset:128
  v_pk_fma_f32 v[20:21], v[24:25], v[50:51], v[64:65]
  v_pk_fma_f32 v[22:23], v[26:27], v[50:51], v[66:67]
  v_pk_fma_f32 v[20:21], v[26:27], v[58:59], v[20:21]
  v_pk_fma_f32 v[26:27], v[24:25], v[52:53], v[22:23]
  v_mov_b32 v24, v20
  v_mov_b32 v25, v21
  v_pk_mul_f32 v[28:29], v[68:69], v[54:55]
  v_pk_mul_f32 v[30:31], v[70:71], v[54:55]
  v_pk_fma_f32 v[28:29], v[70:71], v[60:61], v[28:29]
  v_pk_fma_f32 v[70:71], v[68:69], v[56:57], v[30:31]
  v_mov_b32 v68, v28
  v_mov_b32 v69, v29
  ds_write_b64 v62, v[68:69] offset:272
  ds_write_b64 v62, v[70:71] offset:400
  v_pk_fma_f32 v[20:21], v[24:25], v[50:51], v[68:69]
  v_pk_fma_f32 v[22:23], v[26:27], v[50:51], v[70:71]
  v_pk_fma_f32 v[20:21], v[26:27], v[58:59], v[20:21]
  v_pk_fma_f32 v[26:27], v[24:25], v[52:53], v[22:23]
  v_mov_b32 v24, v20
  v_mov_b32 v25, v21
  v_pk_mul_f32 v[28:29], v[72:73], v[54:55]
  v_pk_mul_f32 v[30:31], v[74:75], v[54:55]
  v_pk_fma_f32 v[28:29], v[74:75], v[60:61], v[28:29]
  v_pk_fma_f32 v[74:75], v[72:73], v[56:57], v[30:31]
  v_mov_b32 v72, v28
  v_mov_b32 v73, v29
  ds_write_b64 v62, v[72:73] offset:544
  ds_write_b64 v62, v[74:75] offset:672
  v_pk_fma_f32 v[20:21], v[24:25], v[50:51], v[72:73]
  v_pk_fma_f32 v[22:23], v[26:27], v[50:51], v[74:75]
  v_pk_fma_f32 v[20:21], v[26:27], v[58:59], v[20:21]
  v_pk_fma_f32 v[26:27], v[24:25], v[52:53], v[22:23]
  v_mov_b32 v24, v20
  v_mov_b32 v25, v21
  v_pk_mul_f32 v[28:29], v[76:77], v[54:55]
  v_pk_mul_f32 v[30:31], v[78:79], v[54:55]
  v_pk_fma_f32 v[28:29], v[78:79], v[60:61], v[28:29]
  v_pk_fma_f32 v[78:79], v[76:77], v[56:57], v[30:31]
  v_mov_b32 v76, v28
  v_mov_b32 v77, v29
  ds_write_b64 v62, v[76:77] offset:816
  ds_write_b64 v62, v[78:79] offset:944
  v_pk_fma_f32 v[20:21], v[24:25], v[50:51], v[76:77]
  v_pk_fma_f32 v[22:23], v[26:27], v[50:51], v[78:79]
  v_pk_fma_f32 v[20:21], v[26:27], v[58:59], v[20:21]
  v_pk_fma_f32 v[26:27], v[24:25], v[52:53], v[22:23]
  v_mov_b32 v24, v20
  v_mov_b32 v25, v21
  v_pk_mul_f32 v[28:29], v[80:81], v[54:55]
  v_pk_mul_f32 v[30:31], v[82:83], v[54:55]
  v_pk_fma_f32 v[28:29], v[82:83], v[60:61], v[28:29]
  v_pk_fma_f32 v[82:83], v[80:81], v[56:57], v[30:31]
  v_mov_b32 v80, v28
  v_mov_b32 v81, v29
  ds_write_b64 v62, v[80:81] offset:1088
  ds_write_b64 v62, v[82:83] offset:1216
  v_pk_fma_f32 v[20:21], v[24:25], v[50:51], v[80:81]
  v_pk_fma_f32 v[22:23], v[26:27], v[50:51], v[82:83]
  v_pk_fma_f32 v[20:21], v[26:27], v[58:59], v[20:21]
  v_pk_fma_f32 v[26:27], v[24:25], v[52:53], v[22:23]
  v_mov_b32 v24, v20
  v_mov_b32 v25, v21
  v_pk_mul_f32 v[28:29], v[84:85], v[54:55]
  v_pk_mul_f32 v[30:31], v[86:87], v[54:55]
  v_pk_fma_f32 v[28:29], v[86:87], v[60:61], v[28:29]
  v_pk_fma_f32 v[86:87], v[84:85], v[56:57], v[30:31]
  v_mov_b32 v84, v28
  v_mov_b32 v85, v29
  ds_write_b64 v62, v[84:85] offset:1360
  ds_write_b64 v62, v[86:87] offset:1488
  v_pk_fma_f32 v[20:21], v[24:25], v[50:51], v[84:85]
  v_pk_fma_f32 v[22:23], v[26:27], v[50:51], v[86:87]
  v_pk_fma_f32 v[20:21], v[26:27], v[58:59], v[20:21]
  v_pk_fma_f32 v[26:27], v[24:25], v[52:53], v[22:23]
  v_mov_b32 v24, v20
  v_mov_b32 v25, v21
  v_pk_mul_f32 v[28:29], v[88:89], v[54:55]
  v_pk_mul_f32 v[30:31], v[90:91], v[54:55]
  v_pk_fma_f32 v[28:29], v[90:91], v[60:61], v[28:29]
  v_pk_fma_f32 v[90:91], v[88:89], v[56:57], v[30:31]
  v_mov_b32 v88, v28
  v_mov_b32 v89, v29
  ds_write_b64 v62, v[88:89] offset:1632
  ds_write_b64 v62, v[90:91] offset:1760
  v_pk_fma_f32 v[20:21], v[24:25], v[50:51], v[88:89]
  v_pk_fma_f32 v[22:23], v[26:27], v[50:51], v[90:91]
  v_pk_fma_f32 v[20:21], v[26:27], v[58:59], v[20:21]
  v_pk_fma_f32 v[26:27], v[24:25], v[52:53], v[22:23]
  v_mov_b32 v24, v20
  v_mov_b32 v25, v21
  v_pk_mul_f32 v[28:29], v[92:93], v[54:55]
  v_pk_mul_f32 v[30:31], v[94:95], v[54:55]
  v_pk_fma_f32 v[28:29], v[94:95], v[60:61], v[28:29]
  v_pk_fma_f32 v[94:95], v[92:93], v[56:57], v[30:31]
  v_mov_b32 v92, v28
  v_mov_b32 v93, v29
  ds_write_b64 v62, v[92:93] offset:1904
  ds_write_b64 v62, v[94:95] offset:2032
  v_pk_fma_f32 v[20:21], v[24:25], v[50:51], v[92:93]
  v_pk_fma_f32 v[22:23], v[26:27], v[50:51], v[94:95]
  v_pk_fma_f32 v[20:21], v[26:27], v[58:59], v[20:21]
  v_pk_fma_f32 v[26:27], v[24:25], v[52:53], v[22:23]
  v_mov_b32 v24, v20
  v_mov_b32 v25, v21
  v_pk_mul_f32 v[28:29], v[96:97], v[54:55]
  v_pk_mul_f32 v[30:31], v[98:99], v[54:55]
  v_pk_fma_f32 v[28:29], v[98:99], v[60:61], v[28:29]
  v_pk_fma_f32 v[98:99], v[96:97], v[56:57], v[30:31]
  v_mov_b32 v96, v28
  v_mov_b32 v97, v29
  ds_write_b64 v62, v[96:97] offset:2176
  ds_write_b64 v62, v[98:99] offset:2304
  v_pk_fma_f32 v[20:21], v[24:25], v[50:51], v[96:97]
  v_pk_fma_f32 v[22:23], v[26:27], v[50:51], v[98:99]
  v_pk_fma_f32 v[20:21], v[26:27], v[58:59], v[20:21]
  v_pk_fma_f32 v[26:27], v[24:25], v[52:53], v[22:23]
  v_mov_b32 v24, v20
  v_mov_b32 v25, v21
  v_pk_mul_f32 v[28:29], v[100:101], v[54:55]
  v_pk_mul_f32 v[30:31], v[102:103], v[54:55]
  v_pk_fma_f32 v[28:29], v[102:103], v[60:61], v[28:29]
  v_pk_fma_f32 v[102:103], v[100:101], v[56:57], v[30:31]
  v_mov_b32 v100, v28
  v_mov_b32 v101, v29
  ds_write_b64 v62, v[100:101] offset:2448
  ds_write_b64 v62, v[102:103] offset:2576
  v_pk_fma_f32 v[20:21], v[24:25], v[50:51], v[100:101]
  v_pk_fma_f32 v[22:23], v[26:27], v[50:51], v[102:103]
  v_pk_fma_f32 v[20:21], v[26:27], v[58:59], v[20:21]
  v_pk_fma_f32 v[26:27], v[24:25], v[52:53], v[22:23]
  v_mov_b32 v24, v20
  v_mov_b32 v25, v21
  v_pk_mul_f32 v[28:29], v[104:105], v[54:55]
  v_pk_mul_f32 v[30:31], v[106:107], v[54:55]
  v_pk_fma_f32 v[28:29], v[106:107], v[60:61], v[28:29]
  v_pk_fma_f32 v[106:107], v[104:105], v[56:57], v[30:31]
  v_mov_b32 v104, v28
  v_mov_b32 v105, v29
  ds_write_b64 v62, v[104:105] offset:2720
  ds_write_b64 v62, v[106:107] offset:2848
  v_pk_fma_f32 v[20:21], v[24:25], v[50:51], v[104:105]
  v_pk_fma_f32 v[22:23], v[26:27], v[50:51], v[106:107]
  v_pk_fma_f32 v[20:21], v[26:27], v[58:59], v[20:21]
  v_pk_fma_f32 v[26:27], v[24:25], v[52:53], v[22:23]
  v_mov_b32 v24, v20
  v_mov_b32 v25, v21
  v_pk_mul_f32 v[28:29], v[108:109], v[54:55]
  v_pk_mul_f32 v[30:31], v[110:111], v[54:55]
  v_pk_fma_f32 v[28:29], v[110:111], v[60:61], v[28:29]
  v_pk_fma_f32 v[110:111], v[108:109], v[56:57], v[30:31]
  v_mov_b32 v108, v28
  v_mov_b32 v109, v29
  ds_write_b64 v62, v[108:109] offset:2992
  ds_write_b64 v62, v[110:111] offset:3120
  v_pk_fma_f32 v[20:21], v[24:25], v[50:51], v[108:109]
  v_pk_fma_f32 v[22:23], v[26:27], v[50:51], v[110:111]
  v_pk_fma_f32 v[20:21], v[26:27], v[58:59], v[20:21]
  v_pk_fma_f32 v[26:27], v[24:25], v[52:53], v[22:23]
  v_mov_b32 v24, v20
  v_mov_b32 v25, v21
  v_pk_mul_f32 v[28:29], v[112:113], v[54:55]
  v_pk_mul_f32 v[30:31], v[114:115], v[54:55]
  v_pk_fma_f32 v[28:29], v[114:115], v[60:61], v[28:29]
  v_pk_fma_f32 v[114:115], v[112:113], v[56:57], v[30:31]
  v_mov_b32 v112, v28
  v_mov_b32 v113, v29
  ds_write_b64 v62, v[112:113] offset:3264
  ds_write_b64 v62, v[114:115] offset:3392
  v_pk_fma_f32 v[20:21], v[24:25], v[50:51], v[112:113]
  v_pk_fma_f32 v[22:23], v[26:27], v[50:51], v[114:115]
  v_pk_fma_f32 v[20:21], v[26:27], v[58:59], v[20:21]
  v_pk_fma_f32 v[26:27], v[24:25], v[52:53], v[22:23]
  v_mov_b32 v24, v20
  v_mov_b32 v25, v21
  v_pk_mul_f32 v[28:29], v[116:117], v[54:55]
  v_pk_mul_f32 v[30:31], v[118:119], v[54:55]
  v_pk_fma_f32 v[28:29], v[118:119], v[60:61], v[28:29]
  v_pk_fma_f32 v[118:119], v[116:117], v[56:57], v[30:31]
  v_mov_b32 v116, v28
  v_mov_b32 v117, v29
  ds_write_b64 v62, v[116:117] offset:3536
  ds_write_b64 v62, v[118:119] offset:3664
  v_pk_fma_f32 v[20:21], v[24:25], v[50:51], v[116:117]
  v_pk_fma_f32 v[22:23], v[26:27], v[50:51], v[118:119]
  v_pk_fma_f32 v[20:21], v[26:27], v[58:59], v[20:21]
  v_pk_fma_f32 v[26:27], v[24:25], v[52:53], v[22:23]
  v_mov_b32 v24, v20
  v_mov_b32 v25, v21
  v_pk_mul_f32 v[28:29], v[120:121], v[54:55]
  v_pk_mul_f32 v[30:31], v[122:123], v[54:55]
  v_pk_fma_f32 v[28:29], v[122:123], v[60:61], v[28:29]
  v_pk_fma_f32 v[122:123], v[120:121], v[56:57], v[30:31]
  v_mov_b32 v120, v28
  v_mov_b32 v121, v29
  ds_write_b64 v62, v[120:121] offset:3808
  ds_write_b64 v62, v[122:123] offset:3936
  v_pk_fma_f32 v[20:21], v[24:25], v[50:51], v[120:121]
  v_pk_fma_f32 v[22:23], v[26:27], v[50:51], v[122:123]
  v_pk_fma_f32 v[20:21], v[26:27], v[58:59], v[20:21]
  v_pk_fma_f32 v[26:27], v[24:25], v[52:53], v[22:23]
  v_mov_b32 v24, v20
  v_mov_b32 v25, v21
  v_pk_mul_f32 v[28:29], v[124:125], v[54:55]
  v_pk_mul_f32 v[30:31], v[126:127], v[54:55]
  v_pk_fma_f32 v[28:29], v[126:127], v[60:61], v[28:29]
  v_pk_fma_f32 v[126:127], v[124:125], v[56:57], v[30:31]
  v_mov_b32 v124, v28
  v_mov_b32 v125, v29
  ds_write_b64 v62, v[124:125] offset:4080
  ds_write_b64 v62, v[126:127] offset:4208
  v_pk_fma_f32 v[20:21], v[24:25], v[50:51], v[124:125]
  v_pk_fma_f32 v[22:23], v[26:27], v[50:51], v[126:127]
  v_pk_fma_f32 v[20:21], v[26:27], v[58:59], v[20:21]
  v_pk_fma_f32 v[26:27], v[24:25], v[52:53], v[22:23]
  v_mov_b32 v24, v20
  v_mov_b32 v25, v21
  v_lshlrev_b32 v39, 8, v34
  v_lshl_add_u32 v39, v3, 4, v39
  v_add_u32 v39, 69632, v39
  ds_write_b128 v39, v[24:27]
  s_waitcnt lgkmcnt(0)
  s_barrier
  v_lshlrev_b32 v63, 4, v3
  v_add_u32 v63, 69632, v63
  ds_read_b128 v[64:67], v63 offset:0
  ds_read_b128 v[68:71], v63 offset:256
  ds_read_b128 v[72:75], v63 offset:512
  ds_read_b128 v[76:79], v63 offset:768
  ds_read_b128 v[80:83], v63 offset:1024
  ds_read_b128 v[84:87], v63 offset:1280
  ds_read_b128 v[88:91], v63 offset:1536
  ds_read_b128 v[92:95], v63 offset:1792
  ds_read_b128 v[96:99], v63 offset:2048
  ds_read_b128 v[100:103], v63 offset:2304
  ds_read_b128 v[104:107], v63 offset:2560
  ds_read_b128 v[108:111], v63 offset:2816
  ds_read_b128 v[112:115], v63 offset:3072
  ds_read_b128 v[116:119], v63 offset:3328
  ds_read_b128 v[120:123], v63 offset:3584
  ds_read_b128 v[124:127], v63 offset:3840
  s_waitcnt lgkmcnt(0)
  v_mov_b32 v24, 0
  v_mov_b32 v25, 0
  v_mov_b32 v26, 0
  v_mov_b32 v27, 0
  v_pk_fma_f32 v[20:21], v[24:25], v[8:9], v[64:65]
  v_pk_fma_f32 v[22:23], v[26:27], v[8:9], v[66:67]
  v_pk_fma_f32 v[20:21], v[26:27], v[12:13], v[20:21]
  v_pk_fma_f32 v[26:27], v[24:25], v[10:11], v[22:23]
  v_mov_b32 v24, v20
  v_mov_b32 v25, v21
  v_pk_fma_f32 v[20:21], v[24:25], v[8:9], v[68:69]
  v_pk_fma_f32 v[22:23], v[26:27], v[8:9], v[70:71]
  v_pk_fma_f32 v[20:21], v[26:27], v[12:13], v[20:21]
  v_pk_fma_f32 v[26:27], v[24:25], v[10:11], v[22:23]
  v_mov_b32 v24, v20
  v_mov_b32 v25, v21
  v_pk_fma_f32 v[20:21], v[24:25], v[8:9], v[72:73]
  v_pk_fma_f32 v[22:23], v[26:27], v[8:9], v[74:75]
  v_pk_fma_f32 v[20:21], v[26:27], v[12:13], v[20:21]
  v_pk_fma_f32 v[26:27], v[24:25], v[10:11], v[22:23]
  v_mov_b32 v24, v20
  v_mov_b32 v25, v21
  v_pk_fma_f32 v[20:21], v[24:25], v[8:9], v[76:77]
  v_pk_fma_f32 v[22:23], v[26:27], v[8:9], v[78:79]
  v_pk_fma_f32 v[20:21], v[26:27], v[12:13], v[20:21]
  v_pk_fma_f32 v[26:27], v[24:25], v[10:11], v[22:23]
  v_mov_b32 v24, v20
  v_mov_b32 v25, v21
  v_pk_fma_f32 v[20:21], v[24:25], v[8:9], v[80:81]
  v_pk_fma_f32 v[22:23], v[26:27], v[8:9], v[82:83]
  v_pk_fma_f32 v[20:21], v[26:27], v[12:13], v[20:21]
  v_pk_fma_f32 v[26:27], v[24:25], v[10:11], v[22:23]
  v_mov_b32 v24, v20
  v_mov_b32 v25, v21
  v_pk_fma_f32 v[20:21], v[24:25], v[8:9], v[84:85]
  v_pk_fma_f32 v[22:23], v[26:27], v[8:9], v[86:87]
  v_pk_fma_f32 v[20:21], v[26:27], v[12:13], v[20:21]
  v_pk_fma_f32 v[26:27], v[24:25], v[10:11], v[22:23]
  v_mov_b32 v24, v20
  v_mov_b32 v25, v21
  v_pk_fma_f32 v[20:21], v[24:25], v[8:9], v[88:89]
  v_pk_fma_f32 v[22:23], v[26:27], v[8:9], v[90:91]
  v_pk_fma_f32 v[20:21], v[26:27], v[12:13], v[20:21]
  v_pk_fma_f32 v[26:27], v[24:25], v[10:11], v[22:23]
  v_mov_b32 v24, v20
  v_mov_b32 v25, v21
  v_pk_fma_f32 v[20:21], v[24:25], v[8:9], v[92:93]
  v_pk_fma_f32 v[22:23], v[26:27], v[8:9], v[94:95]
  v_pk_fma_f32 v[20:21], v[26:27], v[12:13], v[20:21]
  v_pk_fma_f32 v[26:27], v[24:25], v[10:11], v[22:23]
  v_mov_b32 v24, v20
  v_mov_b32 v25, v21
  v_pk_fma_f32 v[20:21], v[24:25], v[8:9], v[96:97]
  v_pk_fma_f32 v[22:23], v[26:27], v[8:9], v[98:99]
  v_pk_fma_f32 v[20:21], v[26:27], v[12:13], v[20:21]
  v_pk_fma_f32 v[26:27], v[24:25], v[10:11], v[22:23]
  v_mov_b32 v24, v20
  v_mov_b32 v25, v21
  v_pk_fma_f32 v[20:21], v[24:25], v[8:9], v[100:101]
  v_pk_fma_f32 v[22:23], v[26:27], v[8:9], v[102:103]
  v_pk_fma_f32 v[20:21], v[26:27], v[12:13], v[20:21]
  v_pk_fma_f32 v[26:27], v[24:25], v[10:11], v[22:23]
  v_mov_b32 v24, v20
  v_mov_b32 v25, v21
  v_pk_fma_f32 v[20:21], v[24:25], v[8:9], v[104:105]
  v_pk_fma_f32 v[22:23], v[26:27], v[8:9], v[106:107]
  v_pk_fma_f32 v[20:21], v[26:27], v[12:13], v[20:21]
  v_pk_fma_f32 v[26:27], v[24:25], v[10:11], v[22:23]
  v_mov_b32 v24, v20
  v_mov_b32 v25, v21
  v_pk_fma_f32 v[20:21], v[24:25], v[8:9], v[108:109]
  v_pk_fma_f32 v[22:23], v[26:27], v[8:9], v[110:111]
  v_pk_fma_f32 v[20:21], v[26:27], v[12:13], v[20:21]
  v_pk_fma_f32 v[26:27], v[24:25], v[10:11], v[22:23]
  v_mov_b32 v24, v20
  v_mov_b32 v25, v21
  v_pk_fma_f32 v[20:21], v[24:25], v[8:9], v[112:113]
  v_pk_fma_f32 v[22:23], v[26:27], v[8:9], v[114:115]
  v_pk_fma_f32 v[20:21], v[26:27], v[12:13], v[20:21]
  v_pk_fma_f32 v[26:27], v[24:25], v[10:11], v[22:23]
  v_mov_b32 v24, v20
  v_mov_b32 v25, v21
  v_pk_fma_f32 v[20:21], v[24:25], v[8:9], v[116:117]
  v_pk_fma_f32 v[22:23], v[26:27], v[8:9], v[118:119]
  v_pk_fma_f32 v[20:21], v[26:27], v[12:13], v[20:21]
  v_pk_fma_f32 v[26:27], v[24:25], v[10:11], v[22:23]
  v_mov_b32 v24, v20
  v_mov_b32 v25, v21
  v_pk_fma_f32 v[20:21], v[24:25], v[8:9], v[120:121]
  v_pk_fma_f32 v[22:23], v[26:27], v[8:9], v[122:123]
  v_pk_fma_f32 v[20:21], v[26:27], v[12:13], v[20:21]
  v_pk_fma_f32 v[26:27], v[24:25], v[10:11], v[22:23]
  v_mov_b32 v24, v20
  v_mov_b32 v25, v21
  v_pk_fma_f32 v[20:21], v[24:25], v[8:9], v[124:125]
  v_pk_fma_f32 v[22:23], v[26:27], v[8:9], v[126:127]
  v_pk_fma_f32 v[20:21], v[26:27], v[12:13], v[20:21]
  v_pk_fma_f32 v[26:27], v[24:25], v[10:11], v[22:23]
  v_mov_b32 v24, v20
  v_mov_b32 v25, v21
  s_add_u32 s40, s36, 0x2410000
  s_addc_u32 s41, s37, 0
  s_mov_b32 s42, 0x10000
  s_mov_b32 s43, 0x00020000
  s_mov_b32 s44, s34
  s_mov_b32 s45, s35
  s_mov_b32 s46, 0x100
  s_mov_b32 s47, 0x00020000
  s_lshl_b32 s74, s58, 8
  v_lshl_add_u32 v39, v3, 4, s74
  s_lshl_b32 s75, s57, 13
  s_lshl_b32 s76, s58, 2
  s_cmp_lg_u32 s56, 0
  s_cbranch_scc1 K1_nopub_2
  s_mov_b64 s[82:83], exec
  s_mov_b64 exec, 0xffff
  buffer_store_dwordx4 v[24:27], v39, s[40:43], s75 offen sc1
  s_waitcnt vmcnt(0)
  s_mov_b64 exec, 1
  s_lshl_b32 s77, 1, s57
  v_mov_b32 v20, s77
  v_mov_b32 v21, 0
  buffer_atomic_or v20, v21, s[44:47], s76 offen sc1
  s_mov_b64 exec, s[82:83]
K1_nopub_2:
  s_mov_b32 s48, s28
  s_mov_b32 s49, s29
  s_mov_b32 s50, 0x700000
  s_mov_b32 s51, 0x00020000
  s_lshl_b32 s74, s2, 2
  s_add_u32 s74, s74, s56
  s_mul_i32 s77, s74, 7168
  v_min_u32 v101, 55, v1
  v_lshlrev_b32 v101, 7, v101
  buffer_load_dword v100, v101, s[48:51], s77 offen
  s_mov_b32 s48, s14
  s_mov_b32 s49, s15
  s_mov_b32 s50, 0x200000
  s_mov_b32 s51, 0x00020000
  s_lshl_b32 s77, s74, 11
  v_lshlrev_b32 v101, 7, v3
  buffer_load_dword v100, v101, s[48:51], s77 offen
  s_mov_b32 s48, s16
  s_mov_b32 s49, s17
  s_mov_b32 s50, 0x200000
  s_mov_b32 s51, 0x00020000
  buffer_load_dword v100, v101, s[48:51], s77 offen
  s_mov_b32 s48, s36
  s_mov_b32 s49, s37
  s_mov_b32 s50, 0xe00000
  s_mov_b32 s51, 0x00020000
  s_lshl_b32 s74, s57, 1
  s_lshr_b32 s77, s56, 1
  s_add_u32 s74, s74, s77
  s_mul_i32 s74, s74, 917504
  s_and_b32 s77, s56, 1
  s_lshl_b32 s77, s77, 13
  s_add_u32 s74, s74, s77
  v_lshlrev_b32 v64, 7, v3
  v_lshl_add_u32 v64, v4, 3, v64
  v_add_u32 v98, s74, v64
  s_mul_i32 s77, s58, 112
  s_add_u32 s78, s77, 0
  s_lshr_b32 s79, s78, 6
  s_lshl_b32 s79, s79, 14
  s_and_b32 s78, s78, 63
  s_lshl_b32 s78, s78, 1
  s_add_u32 s62, s79, s78
  s_add_u32 s78, s77, 16
  s_lshr_b32 s79, s78, 6
  s_lshl_b32 s79, s79, 14
  s_and_b32 s78, s78, 63
  s_lshl_b32 s78, s78, 1
  s_add_u32 s63, s79, s78
  s_add_u32 s78, s77, 32
  s_lshr_b32 s79, s78, 6
  s_lshl_b32 s79, s79, 14
  s_and_b32 s78, s78, 63
  s_lshl_b32 s78, s78, 1
  s_add_u32 s64, s79, s78
  s_add_u32 s78, s77, 48
  s_lshr_b32 s79, s78, 6
  s_lshl_b32 s79, s79, 14
  s_and_b32 s78, s78, 63
  s_lshl_b32 s78, s78, 1
  s_add_u32 s65, s79, s78
  s_add_u32 s78, s77, 64
  s_lshr_b32 s79, s78, 6
  s_lshl_b32 s79, s79, 14
  s_and_b32 s78, s78, 63
  s_lshl_b32 s78, s78, 1
  s_add_u32 s66, s79, s78
  s_add_u32 s78, s77, 80
  s_lshr_b32 s79, s78, 6
  s_lshl_b32 s79, s79, 14
  s_and_b32 s78, s78, 63
  s_lshl_b32 s78, s78, 1
  s_add_u32 s67, s79, s78
  s_add_u32 s78, s77, 96
  s_lshr_b32 s79, s78, 6
  s_lshl_b32 s79, s79, 14
  s_and_b32 s78, s78, 63
  s_lshl_b32 s78, s78, 1
  s_add_u32 s68, s79, s78
  s_mov_b32 s74, 0xbfb8aa3b
  s_mov_b32 s75, 0xbfb8aa3b
  s_mov_b32 s78, 1.0
  s_mov_b32 s79, 1.0
  v_cvt_pk_bf16_f32 v64, v128, v129
  v_cvt_pk_bf16_f32 v65, v130, v131
  v_lshlrev_b32 v66, 16, v64
  v_and_b32 v67, 0xffff0000, v64
  v_lshlrev_b32 v68, 16, v65
  v_and_b32 v69, 0xffff0000, v65
  v_pk_mul_f32 v[70:71], v[66:67], s[74:75]
  v_pk_mul_f32 v[72:73], v[68:69], s[74:75]
  v_exp_f32 v70, v70
  v_exp_f32 v71, v71
  v_exp_f32 v72, v72
  v_exp_f32 v73, v73
  v_accvgpr_read_b32 v78, a0
  v_accvgpr_read_b32 v79, a1
  v_accvgpr_read_b32 v80, a2
  v_accvgpr_read_b32 v81, a3
  v_pk_add_f32 v[70:71], v[70:71], s[78:79]
  v_pk_add_f32 v[72:73], v[72:73], s[78:79]
  v_rcp_f32 v70, v70
  v_rcp_f32 v71, v71
  v_rcp_f32 v72, v72
  v_rcp_f32 v73, v73
  v_cvt_pk_bf16_f32 v76, v78, v79
  v_cvt_pk_bf16_f32 v77, v80, v81
  v_pk_mul_f32 v[70:71], v[66:67], v[70:71]
  v_pk_mul_f32 v[72:73], v[68:69], v[72:73]
  v_cvt_pk_bf16_f32 v74, v70, v71
  v_cvt_pk_bf16_f32 v75, v72, v73
  v_lshlrev_b32 v66, 16, v74
  v_and_b32 v67, 0xffff0000, v74
  v_lshlrev_b32 v68, 16, v75
  v_and_b32 v69, 0xffff0000, v75
  v_lshlrev_b32 v70, 16, v76
  v_and_b32 v71, 0xffff0000, v76
  v_lshlrev_b32 v72, 16, v77
  v_and_b32 v73, 0xffff0000, v77
  v_pk_mul_f32 v[66:67], v[66:67], v[70:71]
  v_pk_mul_f32 v[68:69], v[68:69], v[72:73]
  v_cvt_pk_bf16_f32 v90, v66, v67
  v_cvt_pk_bf16_f32 v91, v68, v69
  buffer_store_dwordx2 v[90:91], v98, s[48:51], s62 offen
  v_cvt_pk_bf16_f32 v64, v144, v145
  v_cvt_pk_bf16_f32 v65, v146, v147
  v_lshlrev_b32 v66, 16, v64
  v_and_b32 v67, 0xffff0000, v64
  v_lshlrev_b32 v68, 16, v65
  v_and_b32 v69, 0xffff0000, v65
  v_pk_mul_f32 v[70:71], v[66:67], s[74:75]
  v_pk_mul_f32 v[72:73], v[68:69], s[74:75]
  v_exp_f32 v70, v70
  v_exp_f32 v71, v71
  v_exp_f32 v72, v72
  v_exp_f32 v73, v73
  v_accvgpr_read_b32 v78, a16
  v_accvgpr_read_b32 v79, a17
  v_accvgpr_read_b32 v80, a18
  v_accvgpr_read_b32 v81, a19
  v_pk_add_f32 v[70:71], v[70:71], s[78:79]
  v_pk_add_f32 v[72:73], v[72:73], s[78:79]
  v_rcp_f32 v70, v70
  v_rcp_f32 v71, v71
  v_rcp_f32 v72, v72
  v_rcp_f32 v73, v73
  v_cvt_pk_bf16_f32 v76, v78, v79
  v_cvt_pk_bf16_f32 v77, v80, v81
  v_pk_mul_f32 v[70:71], v[66:67], v[70:71]
  v_pk_mul_f32 v[72:73], v[68:69], v[72:73]
  v_cvt_pk_bf16_f32 v74, v70, v71
  v_cvt_pk_bf16_f32 v75, v72, v73
  v_lshlrev_b32 v66, 16, v74
  v_and_b32 v67, 0xffff0000, v74
  v_lshlrev_b32 v68, 16, v75
  v_and_b32 v69, 0xffff0000, v75
  v_lshlrev_b32 v70, 16, v76
  v_and_b32 v71, 0xffff0000, v76
  v_lshlrev_b32 v72, 16, v77
  v_and_b32 v73, 0xffff0000, v77
  v_pk_mul_f32 v[66:67], v[66:67], v[70:71]
  v_pk_mul_f32 v[68:69], v[68:69], v[72:73]
  v_cvt_pk_bf16_f32 v92, v66, v67
  v_cvt_pk_bf16_f32 v93, v68, v69
  buffer_store_dwordx2 v[92:93], v98, s[48:51], s63 offen
  v_cvt_pk_bf16_f32 v64, v160, v161
  v_cvt_pk_bf16_f32 v65, v162, v163
  v_lshlrev_b32 v66, 16, v64
  v_and_b32 v67, 0xffff0000, v64
  v_lshlrev_b32 v68, 16, v65
  v_and_b32 v69, 0xffff0000, v65
  v_pk_mul_f32 v[70:71], v[66:67], s[74:75]
  v_pk_mul_f32 v[72:73], v[68:69], s[74:75]
  v_exp_f32 v70, v70
  v_exp_f32 v71, v71
  v_exp_f32 v72, v72
  v_exp_f32 v73, v73
  v_accvgpr_read_b32 v78, a32
  v_accvgpr_read_b32 v79, a33
  v_accvgpr_read_b32 v80, a34
  v_accvgpr_read_b32 v81, a35
  v_pk_add_f32 v[70:71], v[70:71], s[78:79]
  v_pk_add_f32 v[72:73], v[72:73], s[78:79]
  v_rcp_f32 v70, v70
  v_rcp_f32 v71, v71
  v_rcp_f32 v72, v72
  v_rcp_f32 v73, v73
  v_cvt_pk_bf16_f32 v76, v78, v79
  v_cvt_pk_bf16_f32 v77, v80, v81
  v_pk_mul_f32 v[70:71], v[66:67], v[70:71]
  v_pk_mul_f32 v[72:73], v[68:69], v[72:73]
  v_cvt_pk_bf16_f32 v74, v70, v71
  v_cvt_pk_bf16_f32 v75, v72, v73
  v_lshlrev_b32 v66, 16, v74
  v_and_b32 v67, 0xffff0000, v74
  v_lshlrev_b32 v68, 16, v75
  v_and_b32 v69, 0xffff0000, v75
  v_lshlrev_b32 v70, 16, v76
  v_and_b32 v71, 0xffff0000, v76
  v_lshlrev_b32 v72, 16, v77
  v_and_b32 v73, 0xffff0000, v77
  v_pk_mul_f32 v[66:67], v[66:67], v[70:71]
  v_pk_mul_f32 v[68:69], v[68:69], v[72:73]
  v_cvt_pk_bf16_f32 v94, v66, v67
  v_cvt_pk_bf16_f32 v95, v68, v69
  buffer_store_dwordx2 v[94:95], v98, s[48:51], s64 offen
  v_cvt_pk_bf16_f32 v64, v176, v177
  v_cvt_pk_bf16_f32 v65, v178, v179
  v_lshlrev_b32 v66, 16, v64
  v_and_b32 v67, 0xffff0000, v64
  v_lshlrev_b32 v68, 16, v65
  v_and_b32 v69, 0xffff0000, v65
  v_pk_mul_f32 v[70:71], v[66:67], s[74:75]
  v_pk_mul_f32 v[72:73], v[68:69], s[74:75]
  v_exp_f32 v70, v70
  v_exp_f32 v71, v71
  v_exp_f32 v72, v72
  v_exp_f32 v73, v73
  v_accvgpr_read_b32 v78, a48
  v_accvgpr_read_b32 v79, a49
  v_accvgpr_read_b32 v80, a50
  v_accvgpr_read_b32 v81, a51
  v_pk_add_f32 v[70:71], v[70:71], s[78:79]
  v_pk_add_f32 v[72:73], v[72:73], s[78:79]
  v_rcp_f32 v70, v70
  v_rcp_f32 v71, v71
  v_rcp_f32 v72, v72
  v_rcp_f32 v73, v73
  v_cvt_pk_bf16_f32 v76, v78, v79
  v_cvt_pk_bf16_f32 v77, v80, v81
  v_pk_mul_f32 v[70:71], v[66:67], v[70:71]
  v_pk_mul_f32 v[72:73], v[68:69], v[72:73]
  v_cvt_pk_bf16_f32 v74, v70, v71
  v_cvt_pk_bf16_f32 v75, v72, v73
  v_lshlrev_b32 v66, 16, v74
  v_and_b32 v67, 0xffff0000, v74
  v_lshlrev_b32 v68, 16, v75
  v_and_b32 v69, 0xffff0000, v75
  v_lshlrev_b32 v70, 16, v76
  v_and_b32 v71, 0xffff0000, v76
  v_lshlrev_b32 v72, 16, v77
  v_and_b32 v73, 0xffff0000, v77
  v_pk_mul_f32 v[66:67], v[66:67], v[70:71]
  v_pk_mul_f32 v[68:69], v[68:69], v[72:73]
  v_cvt_pk_bf16_f32 v96, v66, v67
  v_cvt_pk_bf16_f32 v97, v68, v69
  buffer_store_dwordx2 v[96:97], v98, s[48:51], s65 offen
  v_cvt_pk_bf16_f32 v64, v192, v193
  v_cvt_pk_bf16_f32 v65, v194, v195
  v_lshlrev_b32 v66, 16, v64
  v_and_b32 v67, 0xffff0000, v64
  v_lshlrev_b32 v68, 16, v65
  v_and_b32 v69, 0xffff0000, v65
  v_pk_mul_f32 v[70:71], v[66:67], s[74:75]
  v_pk_mul_f32 v[72:73], v[68:69], s[74:75]
  v_exp_f32 v70, v70
  v_exp_f32 v71, v71
  v_exp_f32 v72, v72
  v_exp_f32 v73, v73
  v_accvgpr_read_b32 v78, a64
  v_accvgpr_read_b32 v79, a65
  v_accvgpr_read_b32 v80, a66
  v_accvgpr_read_b32 v81, a67
  v_pk_add_f32 v[70:71], v[70:71], s[78:79]
  v_pk_add_f32 v[72:73], v[72:73], s[78:79]
  v_rcp_f32 v70, v70
  v_rcp_f32 v71, v71
  v_rcp_f32 v72, v72
  v_rcp_f32 v73, v73
  v_cvt_pk_bf16_f32 v76, v78, v79
  v_cvt_pk_bf16_f32 v77, v80, v81
  v_pk_mul_f32 v[70:71], v[66:67], v[70:71]
  v_pk_mul_f32 v[72:73], v[68:69], v[72:73]
  v_cvt_pk_bf16_f32 v74, v70, v71
  v_cvt_pk_bf16_f32 v75, v72, v73
  v_lshlrev_b32 v66, 16, v74
  v_and_b32 v67, 0xffff0000, v74
  v_lshlrev_b32 v68, 16, v75
  v_and_b32 v69, 0xffff0000, v75
  v_lshlrev_b32 v70, 16, v76
  v_and_b32 v71, 0xffff0000, v76
  v_lshlrev_b32 v72, 16, v77
  v_and_b32 v73, 0xffff0000, v77
  v_pk_mul_f32 v[66:67], v[66:67], v[70:71]
  v_pk_mul_f32 v[68:69], v[68:69], v[72:73]
  v_cvt_pk_bf16_f32 v90, v66, v67
  v_cvt_pk_bf16_f32 v91, v68, v69
  buffer_store_dwordx2 v[90:91], v98, s[48:51], s66 offen
  v_cvt_pk_bf16_f32 v64, v208, v209
  v_cvt_pk_bf16_f32 v65, v210, v211
  v_lshlrev_b32 v66, 16, v64
  v_and_b32 v67, 0xffff0000, v64
  v_lshlrev_b32 v68, 16, v65
  v_and_b32 v69, 0xffff0000, v65
  v_pk_mul_f32 v[70:71], v[66:67], s[74:75]
  v_pk_mul_f32 v[72:73], v[68:69], s[74:75]
  v_exp_f32 v70, v70
  v_exp_f32 v71, v71
  v_exp_f32 v72, v72
  v_exp_f32 v73, v73
  v_accvgpr_read_b32 v78, a80
  v_accvgpr_read_b32 v79, a81
  v_accvgpr_read_b32 v80, a82
  v_accvgpr_read_b32 v81, a83
  v_pk_add_f32 v[70:71], v[70:71], s[78:79]
  v_pk_add_f32 v[72:73], v[72:73], s[78:79]
  v_rcp_f32 v70, v70
  v_rcp_f32 v71, v71
  v_rcp_f32 v72, v72
  v_rcp_f32 v73, v73
  v_cvt_pk_bf16_f32 v76, v78, v79
  v_cvt_pk_bf16_f32 v77, v80, v81
  v_pk_mul_f32 v[70:71], v[66:67], v[70:71]
  v_pk_mul_f32 v[72:73], v[68:69], v[72:73]
  v_cvt_pk_bf16_f32 v74, v70, v71
  v_cvt_pk_bf16_f32 v75, v72, v73
  v_lshlrev_b32 v66, 16, v74
  v_and_b32 v67, 0xffff0000, v74
  v_lshlrev_b32 v68, 16, v75
  v_and_b32 v69, 0xffff0000, v75
  v_lshlrev_b32 v70, 16, v76
  v_and_b32 v71, 0xffff0000, v76
  v_lshlrev_b32 v72, 16, v77
  v_and_b32 v73, 0xffff0000, v77
  v_pk_mul_f32 v[66:67], v[66:67], v[70:71]
  v_pk_mul_f32 v[68:69], v[68:69], v[72:73]
  v_cvt_pk_bf16_f32 v92, v66, v67
  v_cvt_pk_bf16_f32 v93, v68, v69
  buffer_store_dwordx2 v[92:93], v98, s[48:51], s67 offen
  v_cvt_pk_bf16_f32 v64, v224, v225
  v_cvt_pk_bf16_f32 v65, v226, v227
  v_lshlrev_b32 v66, 16, v64
  v_and_b32 v67, 0xffff0000, v64
  v_lshlrev_b32 v68, 16, v65
  v_and_b32 v69, 0xffff0000, v65
  v_pk_mul_f32 v[70:71], v[66:67], s[74:75]
  v_pk_mul_f32 v[72:73], v[68:69], s[74:75]
  v_exp_f32 v70, v70
  v_exp_f32 v71, v71
  v_exp_f32 v72, v72
  v_exp_f32 v73, v73
  v_accvgpr_read_b32 v78, a96
  v_accvgpr_read_b32 v79, a97
  v_accvgpr_read_b32 v80, a98
  v_accvgpr_read_b32 v81, a99
  v_pk_add_f32 v[70:71], v[70:71], s[78:79]
  v_pk_add_f32 v[72:73], v[72:73], s[78:79]
  v_rcp_f32 v70, v70
  v_rcp_f32 v71, v71
  v_rcp_f32 v72, v72
  v_rcp_f32 v73, v73
  v_cvt_pk_bf16_f32 v76, v78, v79
  v_cvt_pk_bf16_f32 v77, v80, v81
  v_pk_mul_f32 v[70:71], v[66:67], v[70:71]
  v_pk_mul_f32 v[72:73], v[68:69], v[72:73]
  v_cvt_pk_bf16_f32 v74, v70, v71
  v_cvt_pk_bf16_f32 v75, v72, v73
  v_lshlrev_b32 v66, 16, v74
  v_and_b32 v67, 0xffff0000, v74
  v_lshlrev_b32 v68, 16, v75
  v_and_b32 v69, 0xffff0000, v75
  v_lshlrev_b32 v70, 16, v76
  v_and_b32 v71, 0xffff0000, v76
  v_lshlrev_b32 v72, 16, v77
  v_and_b32 v73, 0xffff0000, v77
  v_pk_mul_f32 v[66:67], v[66:67], v[70:71]
  v_pk_mul_f32 v[68:69], v[68:69], v[72:73]
  v_cvt_pk_bf16_f32 v94, v66, v67
  v_cvt_pk_bf16_f32 v95, v68, v69
  buffer_store_dwordx2 v[94:95], v98, s[48:51], s68 offen
  v_add_u32 v98, 2048, v98
  v_cvt_pk_bf16_f32 v64, v132, v133
  v_cvt_pk_bf16_f32 v65, v134, v135
  v_lshlrev_b32 v66, 16, v64
  v_and_b32 v67, 0xffff0000, v64
  v_lshlrev_b32 v68, 16, v65
  v_and_b32 v69, 0xffff0000, v65
  v_pk_mul_f32 v[70:71], v[66:67], s[74:75]
  v_pk_mul_f32 v[72:73], v[68:69], s[74:75]
  v_exp_f32 v70, v70
  v_exp_f32 v71, v71
  v_exp_f32 v72, v72
  v_exp_f32 v73, v73
  v_accvgpr_read_b32 v78, a4
  v_accvgpr_read_b32 v79, a5
  v_accvgpr_read_b32 v80, a6
  v_accvgpr_read_b32 v81, a7
  v_pk_add_f32 v[70:71], v[70:71], s[78:79]
  v_pk_add_f32 v[72:73], v[72:73], s[78:79]
  v_rcp_f32 v70, v70
  v_rcp_f32 v71, v71
  v_rcp_f32 v72, v72
  v_rcp_f32 v73, v73
  v_cvt_pk_bf16_f32 v76, v78, v79
  v_cvt_pk_bf16_f32 v77, v80, v81
  v_pk_mul_f32 v[70:71], v[66:67], v[70:71]
  v_pk_mul_f32 v[72:73], v[68:69], v[72:73]
  v_cvt_pk_bf16_f32 v74, v70, v71
  v_cvt_pk_bf16_f32 v75, v72, v73
  v_lshlrev_b32 v66, 16, v74
  v_and_b32 v67, 0xffff0000, v74
  v_lshlrev_b32 v68, 16, v75
  v_and_b32 v69, 0xffff0000, v75
  v_lshlrev_b32 v70, 16, v76
  v_and_b32 v71, 0xffff0000, v76
  v_lshlrev_b32 v72, 16, v77
  v_and_b32 v73, 0xffff0000, v77
  v_pk_mul_f32 v[66:67], v[66:67], v[70:71]
  v_pk_mul_f32 v[68:69], v[68:69], v[72:73]
  v_cvt_pk_bf16_f32 v96, v66, v67
  v_cvt_pk_bf16_f32 v97, v68, v69
  buffer_store_dwordx2 v[96:97], v98, s[48:51], s62 offen
  v_cvt_pk_bf16_f32 v64, v148, v149
  v_cvt_pk_bf16_f32 v65, v150, v151
  v_lshlrev_b32 v66, 16, v64
  v_and_b32 v67, 0xffff0000, v64
  v_lshlrev_b32 v68, 16, v65
  v_and_b32 v69, 0xffff0000, v65
  v_pk_mul_f32 v[70:71], v[66:67], s[74:75]
  v_pk_mul_f32 v[72:73], v[68:69], s[74:75]
  v_exp_f32 v70, v70
  v_exp_f32 v71, v71
  v_exp_f32 v72, v72
  v_exp_f32 v73, v73
  v_accvgpr_read_b32 v78, a20
  v_accvgpr_read_b32 v79, a21
  v_accvgpr_read_b32 v80, a22
  v_accvgpr_read_b32 v81, a23
  v_pk_add_f32 v[70:71], v[70:71], s[78:79]
  v_pk_add_f32 v[72:73], v[72:73], s[78:79]
  v_rcp_f32 v70, v70
  v_rcp_f32 v71, v71
  v_rcp_f32 v72, v72
  v_rcp_f32 v73, v73
  v_cvt_pk_bf16_f32 v76, v78, v79
  v_cvt_pk_bf16_f32 v77, v80, v81
  v_pk_mul_f32 v[70:71], v[66:67], v[70:71]
  v_pk_mul_f32 v[72:73], v[68:69], v[72:73]
  v_cvt_pk_bf16_f32 v74, v70, v71
  v_cvt_pk_bf16_f32 v75, v72, v73
  v_lshlrev_b32 v66, 16, v74
  v_and_b32 v67, 0xffff0000, v74
  v_lshlrev_b32 v68, 16, v75
  v_and_b32 v69, 0xffff0000, v75
  v_lshlrev_b32 v70, 16, v76
  v_and_b32 v71, 0xffff0000, v76
  v_lshlrev_b32 v72, 16, v77
  v_and_b32 v73, 0xffff0000, v77
  v_pk_mul_f32 v[66:67], v[66:67], v[70:71]
  v_pk_mul_f32 v[68:69], v[68:69], v[72:73]
  v_cvt_pk_bf16_f32 v90, v66, v67
  v_cvt_pk_bf16_f32 v91, v68, v69
  buffer_store_dwordx2 v[90:91], v98, s[48:51], s63 offen
  v_cvt_pk_bf16_f32 v64, v164, v165
  v_cvt_pk_bf16_f32 v65, v166, v167
  v_lshlrev_b32 v66, 16, v64
  v_and_b32 v67, 0xffff0000, v64
  v_lshlrev_b32 v68, 16, v65
  v_and_b32 v69, 0xffff0000, v65
  v_pk_mul_f32 v[70:71], v[66:67], s[74:75]
  v_pk_mul_f32 v[72:73], v[68:69], s[74:75]
  v_exp_f32 v70, v70
  v_exp_f32 v71, v71
  v_exp_f32 v72, v72
  v_exp_f32 v73, v73
  v_accvgpr_read_b32 v78, a36
  v_accvgpr_read_b32 v79, a37
  v_accvgpr_read_b32 v80, a38
  v_accvgpr_read_b32 v81, a39
  v_pk_add_f32 v[70:71], v[70:71], s[78:79]
  v_pk_add_f32 v[72:73], v[72:73], s[78:79]
  v_rcp_f32 v70, v70
  v_rcp_f32 v71, v71
  v_rcp_f32 v72, v72
  v_rcp_f32 v73, v73
  v_cvt_pk_bf16_f32 v76, v78, v79
  v_cvt_pk_bf16_f32 v77, v80, v81
  v_pk_mul_f32 v[70:71], v[66:67], v[70:71]
  v_pk_mul_f32 v[72:73], v[68:69], v[72:73]
  v_cvt_pk_bf16_f32 v74, v70, v71
  v_cvt_pk_bf16_f32 v75, v72, v73
  v_lshlrev_b32 v66, 16, v74
  v_and_b32 v67, 0xffff0000, v74
  v_lshlrev_b32 v68, 16, v75
  v_and_b32 v69, 0xffff0000, v75
  v_lshlrev_b32 v70, 16, v76
  v_and_b32 v71, 0xffff0000, v76
  v_lshlrev_b32 v72, 16, v77
  v_and_b32 v73, 0xffff0000, v77
  v_pk_mul_f32 v[66:67], v[66:67], v[70:71]
  v_pk_mul_f32 v[68:69], v[68:69], v[72:73]
  v_cvt_pk_bf16_f32 v92, v66, v67
  v_cvt_pk_bf16_f32 v93, v68, v69
  buffer_store_dwordx2 v[92:93], v98, s[48:51], s64 offen
  v_cvt_pk_bf16_f32 v64, v180, v181
  v_cvt_pk_bf16_f32 v65, v182, v183
  v_lshlrev_b32 v66, 16, v64
  v_and_b32 v67, 0xffff0000, v64
  v_lshlrev_b32 v68, 16, v65
  v_and_b32 v69, 0xffff0000, v65
  v_pk_mul_f32 v[70:71], v[66:67], s[74:75]
  v_pk_mul_f32 v[72:73], v[68:69], s[74:75]
  v_exp_f32 v70, v70
  v_exp_f32 v71, v71
  v_exp_f32 v72, v72
  v_exp_f32 v73, v73
  v_accvgpr_read_b32 v78, a52
  v_accvgpr_read_b32 v79, a53
  v_accvgpr_read_b32 v80, a54
  v_accvgpr_read_b32 v81, a55
  v_pk_add_f32 v[70:71], v[70:71], s[78:79]
  v_pk_add_f32 v[72:73], v[72:73], s[78:79]
  v_rcp_f32 v70, v70
  v_rcp_f32 v71, v71
  v_rcp_f32 v72, v72
  v_rcp_f32 v73, v73
  v_cvt_pk_bf16_f32 v76, v78, v79
  v_cvt_pk_bf16_f32 v77, v80, v81
  v_pk_mul_f32 v[70:71], v[66:67], v[70:71]
  v_pk_mul_f32 v[72:73], v[68:69], v[72:73]
  v_cvt_pk_bf16_f32 v74, v70, v71
  v_cvt_pk_bf16_f32 v75, v72, v73
  v_lshlrev_b32 v66, 16, v74
  v_and_b32 v67, 0xffff0000, v74
  v_lshlrev_b32 v68, 16, v75
  v_and_b32 v69, 0xffff0000, v75
  v_lshlrev_b32 v70, 16, v76
  v_and_b32 v71, 0xffff0000, v76
  v_lshlrev_b32 v72, 16, v77
  v_and_b32 v73, 0xffff0000, v77
  v_pk_mul_f32 v[66:67], v[66:67], v[70:71]
  v_pk_mul_f32 v[68:69], v[68:69], v[72:73]
  v_cvt_pk_bf16_f32 v94, v66, v67
  v_cvt_pk_bf16_f32 v95, v68, v69
  buffer_store_dwordx2 v[94:95], v98, s[48:51], s65 offen
  v_cvt_pk_bf16_f32 v64, v196, v197
  v_cvt_pk_bf16_f32 v65, v198, v199
  v_lshlrev_b32 v66, 16, v64
  v_and_b32 v67, 0xffff0000, v64
  v_lshlrev_b32 v68, 16, v65
  v_and_b32 v69, 0xffff0000, v65
  v_pk_mul_f32 v[70:71], v[66:67], s[74:75]
  v_pk_mul_f32 v[72:73], v[68:69], s[74:75]
  v_exp_f32 v70, v70
  v_exp_f32 v71, v71
  v_exp_f32 v72, v72
  v_exp_f32 v73, v73
  v_accvgpr_read_b32 v78, a68
  v_accvgpr_read_b32 v79, a69
  v_accvgpr_read_b32 v80, a70
  v_accvgpr_read_b32 v81, a71
  v_pk_add_f32 v[70:71], v[70:71], s[78:79]
  v_pk_add_f32 v[72:73], v[72:73], s[78:79]
  v_rcp_f32 v70, v70
  v_rcp_f32 v71, v71
  v_rcp_f32 v72, v72
  v_rcp_f32 v73, v73
  v_cvt_pk_bf16_f32 v76, v78, v79
  v_cvt_pk_bf16_f32 v77, v80, v81
  v_pk_mul_f32 v[70:71], v[66:67], v[70:71]
  v_pk_mul_f32 v[72:73], v[68:69], v[72:73]
  v_cvt_pk_bf16_f32 v74, v70, v71
  v_cvt_pk_bf16_f32 v75, v72, v73
  v_lshlrev_b32 v66, 16, v74
  v_and_b32 v67, 0xffff0000, v74
  v_lshlrev_b32 v68, 16, v75
  v_and_b32 v69, 0xffff0000, v75
  v_lshlrev_b32 v70, 16, v76
  v_and_b32 v71, 0xffff0000, v76
  v_lshlrev_b32 v72, 16, v77
  v_and_b32 v73, 0xffff0000, v77
  v_pk_mul_f32 v[66:67], v[66:67], v[70:71]
  v_pk_mul_f32 v[68:69], v[68:69], v[72:73]
  v_cvt_pk_bf16_f32 v96, v66, v67
  v_cvt_pk_bf16_f32 v97, v68, v69
  buffer_store_dwordx2 v[96:97], v98, s[48:51], s66 offen
  v_cvt_pk_bf16_f32 v64, v212, v213
  v_cvt_pk_bf16_f32 v65, v214, v215
  v_lshlrev_b32 v66, 16, v64
  v_and_b32 v67, 0xffff0000, v64
  v_lshlrev_b32 v68, 16, v65
  v_and_b32 v69, 0xffff0000, v65
  v_pk_mul_f32 v[70:71], v[66:67], s[74:75]
  v_pk_mul_f32 v[72:73], v[68:69], s[74:75]
  v_exp_f32 v70, v70
  v_exp_f32 v71, v71
  v_exp_f32 v72, v72
  v_exp_f32 v73, v73
  v_accvgpr_read_b32 v78, a84
  v_accvgpr_read_b32 v79, a85
  v_accvgpr_read_b32 v80, a86
  v_accvgpr_read_b32 v81, a87
  v_pk_add_f32 v[70:71], v[70:71], s[78:79]
  v_pk_add_f32 v[72:73], v[72:73], s[78:79]
  v_rcp_f32 v70, v70
  v_rcp_f32 v71, v71
  v_rcp_f32 v72, v72
  v_rcp_f32 v73, v73
  v_cvt_pk_bf16_f32 v76, v78, v79
  v_cvt_pk_bf16_f32 v77, v80, v81
  v_pk_mul_f32 v[70:71], v[66:67], v[70:71]
  v_pk_mul_f32 v[72:73], v[68:69], v[72:73]
  v_cvt_pk_bf16_f32 v74, v70, v71
  v_cvt_pk_bf16_f32 v75, v72, v73
  v_lshlrev_b32 v66, 16, v74
  v_and_b32 v67, 0xffff0000, v74
  v_lshlrev_b32 v68, 16, v75
  v_and_b32 v69, 0xffff0000, v75
  v_lshlrev_b32 v70, 16, v76
  v_and_b32 v71, 0xffff0000, v76
  v_lshlrev_b32 v72, 16, v77
  v_and_b32 v73, 0xffff0000, v77
  v_pk_mul_f32 v[66:67], v[66:67], v[70:71]
  v_pk_mul_f32 v[68:69], v[68:69], v[72:73]
  v_cvt_pk_bf16_f32 v90, v66, v67
  v_cvt_pk_bf16_f32 v91, v68, v69
  buffer_store_dwordx2 v[90:91], v98, s[48:51], s67 offen
  v_cvt_pk_bf16_f32 v64, v228, v229
  v_cvt_pk_bf16_f32 v65, v230, v231
  v_lshlrev_b32 v66, 16, v64
  v_and_b32 v67, 0xffff0000, v64
  v_lshlrev_b32 v68, 16, v65
  v_and_b32 v69, 0xffff0000, v65
  v_pk_mul_f32 v[70:71], v[66:67], s[74:75]
  v_pk_mul_f32 v[72:73], v[68:69], s[74:75]
  v_exp_f32 v70, v70
  v_exp_f32 v71, v71
  v_exp_f32 v72, v72
  v_exp_f32 v73, v73
  v_accvgpr_read_b32 v78, a100
  v_accvgpr_read_b32 v79, a101
  v_accvgpr_read_b32 v80, a102
  v_accvgpr_read_b32 v81, a103
  v_pk_add_f32 v[70:71], v[70:71], s[78:79]
  v_pk_add_f32 v[72:73], v[72:73], s[78:79]
  v_rcp_f32 v70, v70
  v_rcp_f32 v71, v71
  v_rcp_f32 v72, v72
  v_rcp_f32 v73, v73
  v_cvt_pk_bf16_f32 v76, v78, v79
  v_cvt_pk_bf16_f32 v77, v80, v81
  v_pk_mul_f32 v[70:71], v[66:67], v[70:71]
  v_pk_mul_f32 v[72:73], v[68:69], v[72:73]
  v_cvt_pk_bf16_f32 v74, v70, v71
  v_cvt_pk_bf16_f32 v75, v72, v73
  v_lshlrev_b32 v66, 16, v74
  v_and_b32 v67, 0xffff0000, v74
  v_lshlrev_b32 v68, 16, v75
  v_and_b32 v69, 0xffff0000, v75
  v_lshlrev_b32 v70, 16, v76
  v_and_b32 v71, 0xffff0000, v76
  v_lshlrev_b32 v72, 16, v77
  v_and_b32 v73, 0xffff0000, v77
  v_pk_mul_f32 v[66:67], v[66:67], v[70:71]
  v_pk_mul_f32 v[68:69], v[68:69], v[72:73]
  v_cvt_pk_bf16_f32 v92, v66, v67
  v_cvt_pk_bf16_f32 v93, v68, v69
  buffer_store_dwordx2 v[92:93], v98, s[48:51], s68 offen
  v_add_u32 v98, 2048, v98
  v_cvt_pk_bf16_f32 v64, v136, v137
  v_cvt_pk_bf16_f32 v65, v138, v139
  v_lshlrev_b32 v66, 16, v64
  v_and_b32 v67, 0xffff0000, v64
  v_lshlrev_b32 v68, 16, v65
  v_and_b32 v69, 0xffff0000, v65
  v_pk_mul_f32 v[70:71], v[66:67], s[74:75]
  v_pk_mul_f32 v[72:73], v[68:69], s[74:75]
  v_exp_f32 v70, v70
  v_exp_f32 v71, v71
  v_exp_f32 v72, v72
  v_exp_f32 v73, v73
  v_accvgpr_read_b32 v78, a8
  v_accvgpr_read_b32 v79, a9
  v_accvgpr_read_b32 v80, a10
  v_accvgpr_read_b32 v81, a11
  v_pk_add_f32 v[70:71], v[70:71], s[78:79]
  v_pk_add_f32 v[72:73], v[72:73], s[78:79]
  v_rcp_f32 v70, v70
  v_rcp_f32 v71, v71
  v_rcp_f32 v72, v72
  v_rcp_f32 v73, v73
  v_cvt_pk_bf16_f32 v76, v78, v79
  v_cvt_pk_bf16_f32 v77, v80, v81
  v_pk_mul_f32 v[70:71], v[66:67], v[70:71]
  v_pk_mul_f32 v[72:73], v[68:69], v[72:73]
  v_cvt_pk_bf16_f32 v74, v70, v71
  v_cvt_pk_bf16_f32 v75, v72, v73
  v_lshlrev_b32 v66, 16, v74
  v_and_b32 v67, 0xffff0000, v74
  v_lshlrev_b32 v68, 16, v75
  v_and_b32 v69, 0xffff0000, v75
  v_lshlrev_b32 v70, 16, v76
  v_and_b32 v71, 0xffff0000, v76
  v_lshlrev_b32 v72, 16, v77
  v_and_b32 v73, 0xffff0000, v77
  v_pk_mul_f32 v[66:67], v[66:67], v[70:71]
  v_pk_mul_f32 v[68:69], v[68:69], v[72:73]
  v_cvt_pk_bf16_f32 v94, v66, v67
  v_cvt_pk_bf16_f32 v95, v68, v69
  buffer_store_dwordx2 v[94:95], v98, s[48:51], s62 offen
  v_cvt_pk_bf16_f32 v64, v152, v153
  v_cvt_pk_bf16_f32 v65, v154, v155
  v_lshlrev_b32 v66, 16, v64
  v_and_b32 v67, 0xffff0000, v64
  v_lshlrev_b32 v68, 16, v65
  v_and_b32 v69, 0xffff0000, v65
  v_pk_mul_f32 v[70:71], v[66:67], s[74:75]
  v_pk_mul_f32 v[72:73], v[68:69], s[74:75]
  v_exp_f32 v70, v70
  v_exp_f32 v71, v71
  v_exp_f32 v72, v72
  v_exp_f32 v73, v73
  v_accvgpr_read_b32 v78, a24
  v_accvgpr_read_b32 v79, a25
  v_accvgpr_read_b32 v80, a26
  v_accvgpr_read_b32 v81, a27
  v_pk_add_f32 v[70:71], v[70:71], s[78:79]
  v_pk_add_f32 v[72:73], v[72:73], s[78:79]
  v_rcp_f32 v70, v70
  v_rcp_f32 v71, v71
  v_rcp_f32 v72, v72
  v_rcp_f32 v73, v73
  v_cvt_pk_bf16_f32 v76, v78, v79
  v_cvt_pk_bf16_f32 v77, v80, v81
  v_pk_mul_f32 v[70:71], v[66:67], v[70:71]
  v_pk_mul_f32 v[72:73], v[68:69], v[72:73]
  v_cvt_pk_bf16_f32 v74, v70, v71
  v_cvt_pk_bf16_f32 v75, v72, v73
  v_lshlrev_b32 v66, 16, v74
  v_and_b32 v67, 0xffff0000, v74
  v_lshlrev_b32 v68, 16, v75
  v_and_b32 v69, 0xffff0000, v75
  v_lshlrev_b32 v70, 16, v76
  v_and_b32 v71, 0xffff0000, v76
  v_lshlrev_b32 v72, 16, v77
  v_and_b32 v73, 0xffff0000, v77
  v_pk_mul_f32 v[66:67], v[66:67], v[70:71]
  v_pk_mul_f32 v[68:69], v[68:69], v[72:73]
  v_cvt_pk_bf16_f32 v96, v66, v67
  v_cvt_pk_bf16_f32 v97, v68, v69
  buffer_store_dwordx2 v[96:97], v98, s[48:51], s63 offen
  v_cvt_pk_bf16_f32 v64, v168, v169
  v_cvt_pk_bf16_f32 v65, v170, v171
  v_lshlrev_b32 v66, 16, v64
  v_and_b32 v67, 0xffff0000, v64
  v_lshlrev_b32 v68, 16, v65
  v_and_b32 v69, 0xffff0000, v65
  v_pk_mul_f32 v[70:71], v[66:67], s[74:75]
  v_pk_mul_f32 v[72:73], v[68:69], s[74:75]
  v_exp_f32 v70, v70
  v_exp_f32 v71, v71
  v_exp_f32 v72, v72
  v_exp_f32 v73, v73
  v_accvgpr_read_b32 v78, a40
  v_accvgpr_read_b32 v79, a41
  v_accvgpr_read_b32 v80, a42
  v_accvgpr_read_b32 v81, a43
  v_pk_add_f32 v[70:71], v[70:71], s[78:79]
  v_pk_add_f32 v[72:73], v[72:73], s[78:79]
  v_rcp_f32 v70, v70
  v_rcp_f32 v71, v71
  v_rcp_f32 v72, v72
  v_rcp_f32 v73, v73
  v_cvt_pk_bf16_f32 v76, v78, v79
  v_cvt_pk_bf16_f32 v77, v80, v81
  v_pk_mul_f32 v[70:71], v[66:67], v[70:71]
  v_pk_mul_f32 v[72:73], v[68:69], v[72:73]
  v_cvt_pk_bf16_f32 v74, v70, v71
  v_cvt_pk_bf16_f32 v75, v72, v73
  v_lshlrev_b32 v66, 16, v74
  v_and_b32 v67, 0xffff0000, v74
  v_lshlrev_b32 v68, 16, v75
  v_and_b32 v69, 0xffff0000, v75
  v_lshlrev_b32 v70, 16, v76
  v_and_b32 v71, 0xffff0000, v76
  v_lshlrev_b32 v72, 16, v77
  v_and_b32 v73, 0xffff0000, v77
  v_pk_mul_f32 v[66:67], v[66:67], v[70:71]
  v_pk_mul_f32 v[68:69], v[68:69], v[72:73]
  v_cvt_pk_bf16_f32 v90, v66, v67
  v_cvt_pk_bf16_f32 v91, v68, v69
  buffer_store_dwordx2 v[90:91], v98, s[48:51], s64 offen
  v_cvt_pk_bf16_f32 v64, v184, v185
  v_cvt_pk_bf16_f32 v65, v186, v187
  v_lshlrev_b32 v66, 16, v64
  v_and_b32 v67, 0xffff0000, v64
  v_lshlrev_b32 v68, 16, v65
  v_and_b32 v69, 0xffff0000, v65
  v_pk_mul_f32 v[70:71], v[66:67], s[74:75]
  v_pk_mul_f32 v[72:73], v[68:69], s[74:75]
  v_exp_f32 v70, v70
  v_exp_f32 v71, v71
  v_exp_f32 v72, v72
  v_exp_f32 v73, v73
  v_accvgpr_read_b32 v78, a56
  v_accvgpr_read_b32 v79, a57
  v_accvgpr_read_b32 v80, a58
  v_accvgpr_read_b32 v81, a59
  v_pk_add_f32 v[70:71], v[70:71], s[78:79]
  v_pk_add_f32 v[72:73], v[72:73], s[78:79]
  v_rcp_f32 v70, v70
  v_rcp_f32 v71, v71
  v_rcp_f32 v72, v72
  v_rcp_f32 v73, v73
  v_cvt_pk_bf16_f32 v76, v78, v79
  v_cvt_pk_bf16_f32 v77, v80, v81
  v_pk_mul_f32 v[70:71], v[66:67], v[70:71]
  v_pk_mul_f32 v[72:73], v[68:69], v[72:73]
  v_cvt_pk_bf16_f32 v74, v70, v71
  v_cvt_pk_bf16_f32 v75, v72, v73
  v_lshlrev_b32 v66, 16, v74
  v_and_b32 v67, 0xffff0000, v74
  v_lshlrev_b32 v68, 16, v75
  v_and_b32 v69, 0xffff0000, v75
  v_lshlrev_b32 v70, 16, v76
  v_and_b32 v71, 0xffff0000, v76
  v_lshlrev_b32 v72, 16, v77
  v_and_b32 v73, 0xffff0000, v77
  v_pk_mul_f32 v[66:67], v[66:67], v[70:71]
  v_pk_mul_f32 v[68:69], v[68:69], v[72:73]
  v_cvt_pk_bf16_f32 v92, v66, v67
  v_cvt_pk_bf16_f32 v93, v68, v69
  buffer_store_dwordx2 v[92:93], v98, s[48:51], s65 offen
  v_cvt_pk_bf16_f32 v64, v200, v201
  v_cvt_pk_bf16_f32 v65, v202, v203
  v_lshlrev_b32 v66, 16, v64
  v_and_b32 v67, 0xffff0000, v64
  v_lshlrev_b32 v68, 16, v65
  v_and_b32 v69, 0xffff0000, v65
  v_pk_mul_f32 v[70:71], v[66:67], s[74:75]
  v_pk_mul_f32 v[72:73], v[68:69], s[74:75]
  v_exp_f32 v70, v70
  v_exp_f32 v71, v71
  v_exp_f32 v72, v72
  v_exp_f32 v73, v73
  v_accvgpr_read_b32 v78, a72
  v_accvgpr_read_b32 v79, a73
  v_accvgpr_read_b32 v80, a74
  v_accvgpr_read_b32 v81, a75
  v_pk_add_f32 v[70:71], v[70:71], s[78:79]
  v_pk_add_f32 v[72:73], v[72:73], s[78:79]
  v_rcp_f32 v70, v70
  v_rcp_f32 v71, v71
  v_rcp_f32 v72, v72
  v_rcp_f32 v73, v73
  v_cvt_pk_bf16_f32 v76, v78, v79
  v_cvt_pk_bf16_f32 v77, v80, v81
  v_pk_mul_f32 v[70:71], v[66:67], v[70:71]
  v_pk_mul_f32 v[72:73], v[68:69], v[72:73]
  v_cvt_pk_bf16_f32 v74, v70, v71
  v_cvt_pk_bf16_f32 v75, v72, v73
  v_lshlrev_b32 v66, 16, v74
  v_and_b32 v67, 0xffff0000, v74
  v_lshlrev_b32 v68, 16, v75
  v_and_b32 v69, 0xffff0000, v75
  v_lshlrev_b32 v70, 16, v76
  v_and_b32 v71, 0xffff0000, v76
  v_lshlrev_b32 v72, 16, v77
  v_and_b32 v73, 0xffff0000, v77
  v_pk_mul_f32 v[66:67], v[66:67], v[70:71]
  v_pk_mul_f32 v[68:69], v[68:69], v[72:73]
  v_cvt_pk_bf16_f32 v94, v66, v67
  v_cvt_pk_bf16_f32 v95, v68, v69
  buffer_store_dwordx2 v[94:95], v98, s[48:51], s66 offen
  v_cvt_pk_bf16_f32 v64, v216, v217
  v_cvt_pk_bf16_f32 v65, v218, v219
  v_lshlrev_b32 v66, 16, v64
  v_and_b32 v67, 0xffff0000, v64
  v_lshlrev_b32 v68, 16, v65
  v_and_b32 v69, 0xffff0000, v65
  v_pk_mul_f32 v[70:71], v[66:67], s[74:75]
  v_pk_mul_f32 v[72:73], v[68:69], s[74:75]
  v_exp_f32 v70, v70
  v_exp_f32 v71, v71
  v_exp_f32 v72, v72
  v_exp_f32 v73, v73
  v_accvgpr_read_b32 v78, a88
  v_accvgpr_read_b32 v79, a89
  v_accvgpr_read_b32 v80, a90
  v_accvgpr_read_b32 v81, a91
  v_pk_add_f32 v[70:71], v[70:71], s[78:79]
  v_pk_add_f32 v[72:73], v[72:73], s[78:79]
  v_rcp_f32 v70, v70
  v_rcp_f32 v71, v71
  v_rcp_f32 v72, v72
  v_rcp_f32 v73, v73
  v_cvt_pk_bf16_f32 v76, v78, v79
  v_cvt_pk_bf16_f32 v77, v80, v81
  v_pk_mul_f32 v[70:71], v[66:67], v[70:71]
  v_pk_mul_f32 v[72:73], v[68:69], v[72:73]
  v_cvt_pk_bf16_f32 v74, v70, v71
  v_cvt_pk_bf16_f32 v75, v72, v73
  v_lshlrev_b32 v66, 16, v74
  v_and_b32 v67, 0xffff0000, v74
  v_lshlrev_b32 v68, 16, v75
  v_and_b32 v69, 0xffff0000, v75
  v_lshlrev_b32 v70, 16, v76
  v_and_b32 v71, 0xffff0000, v76
  v_lshlrev_b32 v72, 16, v77
  v_and_b32 v73, 0xffff0000, v77
  v_pk_mul_f32 v[66:67], v[66:67], v[70:71]
  v_pk_mul_f32 v[68:69], v[68:69], v[72:73]
  v_cvt_pk_bf16_f32 v96, v66, v67
  v_cvt_pk_bf16_f32 v97, v68, v69
  buffer_store_dwordx2 v[96:97], v98, s[48:51], s67 offen
  v_cvt_pk_bf16_f32 v64, v232, v233
  v_cvt_pk_bf16_f32 v65, v234, v235
  v_lshlrev_b32 v66, 16, v64
  v_and_b32 v67, 0xffff0000, v64
  v_lshlrev_b32 v68, 16, v65
  v_and_b32 v69, 0xffff0000, v65
  v_pk_mul_f32 v[70:71], v[66:67], s[74:75]
  v_pk_mul_f32 v[72:73], v[68:69], s[74:75]
  v_exp_f32 v70, v70
  v_exp_f32 v71, v71
  v_exp_f32 v72, v72
  v_exp_f32 v73, v73
  v_accvgpr_read_b32 v78, a104
  v_accvgpr_read_b32 v79, a105
  v_accvgpr_read_b32 v80, a106
  v_accvgpr_read_b32 v81, a107
  v_pk_add_f32 v[70:71], v[70:71], s[78:79]
  v_pk_add_f32 v[72:73], v[72:73], s[78:79]
  v_rcp_f32 v70, v70
  v_rcp_f32 v71, v71
  v_rcp_f32 v72, v72
  v_rcp_f32 v73, v73
  v_cvt_pk_bf16_f32 v76, v78, v79
  v_cvt_pk_bf16_f32 v77, v80, v81
  v_pk_mul_f32 v[70:71], v[66:67], v[70:71]
  v_pk_mul_f32 v[72:73], v[68:69], v[72:73]
  v_cvt_pk_bf16_f32 v74, v70, v71
  v_cvt_pk_bf16_f32 v75, v72, v73
  v_lshlrev_b32 v66, 16, v74
  v_and_b32 v67, 0xffff0000, v74
  v_lshlrev_b32 v68, 16, v75
  v_and_b32 v69, 0xffff0000, v75
  v_lshlrev_b32 v70, 16, v76
  v_and_b32 v71, 0xffff0000, v76
  v_lshlrev_b32 v72, 16, v77
  v_and_b32 v73, 0xffff0000, v77
  v_pk_mul_f32 v[66:67], v[66:67], v[70:71]
  v_pk_mul_f32 v[68:69], v[68:69], v[72:73]
  v_cvt_pk_bf16_f32 v90, v66, v67
  v_cvt_pk_bf16_f32 v91, v68, v69
  buffer_store_dwordx2 v[90:91], v98, s[48:51], s68 offen
  v_add_u32 v98, 2048, v98
  v_cvt_pk_bf16_f32 v64, v140, v141
  v_cvt_pk_bf16_f32 v65, v142, v143
  v_lshlrev_b32 v66, 16, v64
  v_and_b32 v67, 0xffff0000, v64
  v_lshlrev_b32 v68, 16, v65
  v_and_b32 v69, 0xffff0000, v65
  v_pk_mul_f32 v[70:71], v[66:67], s[74:75]
  v_pk_mul_f32 v[72:73], v[68:69], s[74:75]
  v_exp_f32 v70, v70
  v_exp_f32 v71, v71
  v_exp_f32 v72, v72
  v_exp_f32 v73, v73
  v_accvgpr_read_b32 v78, a12
  v_accvgpr_read_b32 v79, a13
  v_accvgpr_read_b32 v80, a14
  v_accvgpr_read_b32 v81, a15
  v_pk_add_f32 v[70:71], v[70:71], s[78:79]
  v_pk_add_f32 v[72:73], v[72:73], s[78:79]
  v_rcp_f32 v70, v70
  v_rcp_f32 v71, v71
  v_rcp_f32 v72, v72
  v_rcp_f32 v73, v73
  v_cvt_pk_bf16_f32 v76, v78, v79
  v_cvt_pk_bf16_f32 v77, v80, v81
  v_pk_mul_f32 v[70:71], v[66:67], v[70:71]
  v_pk_mul_f32 v[72:73], v[68:69], v[72:73]
  v_cvt_pk_bf16_f32 v74, v70, v71
  v_cvt_pk_bf16_f32 v75, v72, v73
  v_lshlrev_b32 v66, 16, v74
  v_and_b32 v67, 0xffff0000, v74
  v_lshlrev_b32 v68, 16, v75
  v_and_b32 v69, 0xffff0000, v75
  v_lshlrev_b32 v70, 16, v76
  v_and_b32 v71, 0xffff0000, v76
  v_lshlrev_b32 v72, 16, v77
  v_and_b32 v73, 0xffff0000, v77
  v_pk_mul_f32 v[66:67], v[66:67], v[70:71]
  v_pk_mul_f32 v[68:69], v[68:69], v[72:73]
  v_cvt_pk_bf16_f32 v92, v66, v67
  v_cvt_pk_bf16_f32 v93, v68, v69
  buffer_store_dwordx2 v[92:93], v98, s[48:51], s62 offen
  v_cvt_pk_bf16_f32 v64, v156, v157
  v_cvt_pk_bf16_f32 v65, v158, v159
  v_lshlrev_b32 v66, 16, v64
  v_and_b32 v67, 0xffff0000, v64
  v_lshlrev_b32 v68, 16, v65
  v_and_b32 v69, 0xffff0000, v65
  v_pk_mul_f32 v[70:71], v[66:67], s[74:75]
  v_pk_mul_f32 v[72:73], v[68:69], s[74:75]
  v_exp_f32 v70, v70
  v_exp_f32 v71, v71
  v_exp_f32 v72, v72
  v_exp_f32 v73, v73
  v_accvgpr_read_b32 v78, a28
  v_accvgpr_read_b32 v79, a29
  v_accvgpr_read_b32 v80, a30
  v_accvgpr_read_b32 v81, a31
  v_pk_add_f32 v[70:71], v[70:71], s[78:79]
  v_pk_add_f32 v[72:73], v[72:73], s[78:79]
  v_rcp_f32 v70, v70
  v_rcp_f32 v71, v71
  v_rcp_f32 v72, v72
  v_rcp_f32 v73, v73
  v_cvt_pk_bf16_f32 v76, v78, v79
  v_cvt_pk_bf16_f32 v77, v80, v81
  v_pk_mul_f32 v[70:71], v[66:67], v[70:71]
  v_pk_mul_f32 v[72:73], v[68:69], v[72:73]
  v_cvt_pk_bf16_f32 v74, v70, v71
  v_cvt_pk_bf16_f32 v75, v72, v73
  v_lshlrev_b32 v66, 16, v74
  v_and_b32 v67, 0xffff0000, v74
  v_lshlrev_b32 v68, 16, v75
  v_and_b32 v69, 0xffff0000, v75
  v_lshlrev_b32 v70, 16, v76
  v_and_b32 v71, 0xffff0000, v76
  v_lshlrev_b32 v72, 16, v77
  v_and_b32 v73, 0xffff0000, v77
  v_pk_mul_f32 v[66:67], v[66:67], v[70:71]
  v_pk_mul_f32 v[68:69], v[68:69], v[72:73]
  v_cvt_pk_bf16_f32 v94, v66, v67
  v_cvt_pk_bf16_f32 v95, v68, v69
  buffer_store_dwordx2 v[94:95], v98, s[48:51], s63 offen
  v_cvt_pk_bf16_f32 v64, v172, v173
  v_cvt_pk_bf16_f32 v65, v174, v175
  v_lshlrev_b32 v66, 16, v64
  v_and_b32 v67, 0xffff0000, v64
  v_lshlrev_b32 v68, 16, v65
  v_and_b32 v69, 0xffff0000, v65
  v_pk_mul_f32 v[70:71], v[66:67], s[74:75]
  v_pk_mul_f32 v[72:73], v[68:69], s[74:75]
  v_exp_f32 v70, v70
  v_exp_f32 v71, v71
  v_exp_f32 v72, v72
  v_exp_f32 v73, v73
  v_accvgpr_read_b32 v78, a44
  v_accvgpr_read_b32 v79, a45
  v_accvgpr_read_b32 v80, a46
  v_accvgpr_read_b32 v81, a47
  v_pk_add_f32 v[70:71], v[70:71], s[78:79]
  v_pk_add_f32 v[72:73], v[72:73], s[78:79]
  v_rcp_f32 v70, v70
  v_rcp_f32 v71, v71
  v_rcp_f32 v72, v72
  v_rcp_f32 v73, v73
  v_cvt_pk_bf16_f32 v76, v78, v79
  v_cvt_pk_bf16_f32 v77, v80, v81
  v_pk_mul_f32 v[70:71], v[66:67], v[70:71]
  v_pk_mul_f32 v[72:73], v[68:69], v[72:73]
  v_cvt_pk_bf16_f32 v74, v70, v71
  v_cvt_pk_bf16_f32 v75, v72, v73
  v_lshlrev_b32 v66, 16, v74
  v_and_b32 v67, 0xffff0000, v74
  v_lshlrev_b32 v68, 16, v75
  v_and_b32 v69, 0xffff0000, v75
  v_lshlrev_b32 v70, 16, v76
  v_and_b32 v71, 0xffff0000, v76
  v_lshlrev_b32 v72, 16, v77
  v_and_b32 v73, 0xffff0000, v77
  v_pk_mul_f32 v[66:67], v[66:67], v[70:71]
  v_pk_mul_f32 v[68:69], v[68:69], v[72:73]
  v_cvt_pk_bf16_f32 v96, v66, v67
  v_cvt_pk_bf16_f32 v97, v68, v69
  buffer_store_dwordx2 v[96:97], v98, s[48:51], s64 offen
  v_cvt_pk_bf16_f32 v64, v188, v189
  v_cvt_pk_bf16_f32 v65, v190, v191
  v_lshlrev_b32 v66, 16, v64
  v_and_b32 v67, 0xffff0000, v64
  v_lshlrev_b32 v68, 16, v65
  v_and_b32 v69, 0xffff0000, v65
  v_pk_mul_f32 v[70:71], v[66:67], s[74:75]
  v_pk_mul_f32 v[72:73], v[68:69], s[74:75]
  v_exp_f32 v70, v70
  v_exp_f32 v71, v71
  v_exp_f32 v72, v72
  v_exp_f32 v73, v73
  v_accvgpr_read_b32 v78, a60
  v_accvgpr_read_b32 v79, a61
  v_accvgpr_read_b32 v80, a62
  v_accvgpr_read_b32 v81, a63
  v_pk_add_f32 v[70:71], v[70:71], s[78:79]
  v_pk_add_f32 v[72:73], v[72:73], s[78:79]
  v_rcp_f32 v70, v70
  v_rcp_f32 v71, v71
  v_rcp_f32 v72, v72
  v_rcp_f32 v73, v73
  v_cvt_pk_bf16_f32 v76, v78, v79
  v_cvt_pk_bf16_f32 v77, v80, v81
  v_pk_mul_f32 v[70:71], v[66:67], v[70:71]
  v_pk_mul_f32 v[72:73], v[68:69], v[72:73]
  v_cvt_pk_bf16_f32 v74, v70, v71
  v_cvt_pk_bf16_f32 v75, v72, v73
  v_lshlrev_b32 v66, 16, v74
  v_and_b32 v67, 0xffff0000, v74
  v_lshlrev_b32 v68, 16, v75
  v_and_b32 v69, 0xffff0000, v75
  v_lshlrev_b32 v70, 16, v76
  v_and_b32 v71, 0xffff0000, v76
  v_lshlrev_b32 v72, 16, v77
  v_and_b32 v73, 0xffff0000, v77
  v_pk_mul_f32 v[66:67], v[66:67], v[70:71]
  v_pk_mul_f32 v[68:69], v[68:69], v[72:73]
  v_cvt_pk_bf16_f32 v90, v66, v67
  v_cvt_pk_bf16_f32 v91, v68, v69
  buffer_store_dwordx2 v[90:91], v98, s[48:51], s65 offen
  v_cvt_pk_bf16_f32 v64, v204, v205
  v_cvt_pk_bf16_f32 v65, v206, v207
  v_lshlrev_b32 v66, 16, v64
  v_and_b32 v67, 0xffff0000, v64
  v_lshlrev_b32 v68, 16, v65
  v_and_b32 v69, 0xffff0000, v65
  v_pk_mul_f32 v[70:71], v[66:67], s[74:75]
  v_pk_mul_f32 v[72:73], v[68:69], s[74:75]
  v_exp_f32 v70, v70
  v_exp_f32 v71, v71
  v_exp_f32 v72, v72
  v_exp_f32 v73, v73
  v_accvgpr_read_b32 v78, a76
  v_accvgpr_read_b32 v79, a77
  v_accvgpr_read_b32 v80, a78
  v_accvgpr_read_b32 v81, a79
  v_pk_add_f32 v[70:71], v[70:71], s[78:79]
  v_pk_add_f32 v[72:73], v[72:73], s[78:79]
  v_rcp_f32 v70, v70
  v_rcp_f32 v71, v71
  v_rcp_f32 v72, v72
  v_rcp_f32 v73, v73
  v_cvt_pk_bf16_f32 v76, v78, v79
  v_cvt_pk_bf16_f32 v77, v80, v81
  v_pk_mul_f32 v[70:71], v[66:67], v[70:71]
  v_pk_mul_f32 v[72:73], v[68:69], v[72:73]
  v_cvt_pk_bf16_f32 v74, v70, v71
  v_cvt_pk_bf16_f32 v75, v72, v73
  v_lshlrev_b32 v66, 16, v74
  v_and_b32 v67, 0xffff0000, v74
  v_lshlrev_b32 v68, 16, v75
  v_and_b32 v69, 0xffff0000, v75
  v_lshlrev_b32 v70, 16, v76
  v_and_b32 v71, 0xffff0000, v76
  v_lshlrev_b32 v72, 16, v77
  v_and_b32 v73, 0xffff0000, v77
  v_pk_mul_f32 v[66:67], v[66:67], v[70:71]
  v_pk_mul_f32 v[68:69], v[68:69], v[72:73]
  v_cvt_pk_bf16_f32 v92, v66, v67
  v_cvt_pk_bf16_f32 v93, v68, v69
  buffer_store_dwordx2 v[92:93], v98, s[48:51], s66 offen
  v_cvt_pk_bf16_f32 v64, v220, v221
  v_cvt_pk_bf16_f32 v65, v222, v223
  v_lshlrev_b32 v66, 16, v64
  v_and_b32 v67, 0xffff0000, v64
  v_lshlrev_b32 v68, 16, v65
  v_and_b32 v69, 0xffff0000, v65
  v_pk_mul_f32 v[70:71], v[66:67], s[74:75]
  v_pk_mul_f32 v[72:73], v[68:69], s[74:75]
  v_exp_f32 v70, v70
  v_exp_f32 v71, v71
  v_exp_f32 v72, v72
  v_exp_f32 v73, v73
  v_accvgpr_read_b32 v78, a92
  v_accvgpr_read_b32 v79, a93
  v_accvgpr_read_b32 v80, a94
  v_accvgpr_read_b32 v81, a95
  v_pk_add_f32 v[70:71], v[70:71], s[78:79]
  v_pk_add_f32 v[72:73], v[72:73], s[78:79]
  v_rcp_f32 v70, v70
  v_rcp_f32 v71, v71
  v_rcp_f32 v72, v72
  v_rcp_f32 v73, v73
  v_cvt_pk_bf16_f32 v76, v78, v79
  v_cvt_pk_bf16_f32 v77, v80, v81
  v_pk_mul_f32 v[70:71], v[66:67], v[70:71]
  v_pk_mul_f32 v[72:73], v[68:69], v[72:73]
  v_cvt_pk_bf16_f32 v74, v70, v71
  v_cvt_pk_bf16_f32 v75, v72, v73
  v_lshlrev_b32 v66, 16, v74
  v_and_b32 v67, 0xffff0000, v74
  v_lshlrev_b32 v68, 16, v75
  v_and_b32 v69, 0xffff0000, v75
  v_lshlrev_b32 v70, 16, v76
  v_and_b32 v71, 0xffff0000, v76
  v_lshlrev_b32 v72, 16, v77
  v_and_b32 v73, 0xffff0000, v77
  v_pk_mul_f32 v[66:67], v[66:67], v[70:71]
  v_pk_mul_f32 v[68:69], v[68:69], v[72:73]
  v_cvt_pk_bf16_f32 v94, v66, v67
  v_cvt_pk_bf16_f32 v95, v68, v69
  buffer_store_dwordx2 v[94:95], v98, s[48:51], s67 offen
  v_cvt_pk_bf16_f32 v64, v236, v237
  v_cvt_pk_bf16_f32 v65, v238, v239
  v_lshlrev_b32 v66, 16, v64
  v_and_b32 v67, 0xffff0000, v64
  v_lshlrev_b32 v68, 16, v65
  v_and_b32 v69, 0xffff0000, v65
  v_pk_mul_f32 v[70:71], v[66:67], s[74:75]
  v_pk_mul_f32 v[72:73], v[68:69], s[74:75]
  v_exp_f32 v70, v70
  v_exp_f32 v71, v71
  v_exp_f32 v72, v72
  v_exp_f32 v73, v73
  v_accvgpr_read_b32 v78, a108
  v_accvgpr_read_b32 v79, a109
  v_accvgpr_read_b32 v80, a110
  v_accvgpr_read_b32 v81, a111
  v_pk_add_f32 v[70:71], v[70:71], s[78:79]
  v_pk_add_f32 v[72:73], v[72:73], s[78:79]
  v_rcp_f32 v70, v70
  v_rcp_f32 v71, v71
  v_rcp_f32 v72, v72
  v_rcp_f32 v73, v73
  v_cvt_pk_bf16_f32 v76, v78, v79
  v_cvt_pk_bf16_f32 v77, v80, v81
  v_pk_mul_f32 v[70:71], v[66:67], v[70:71]
  v_pk_mul_f32 v[72:73], v[68:69], v[72:73]
  v_cvt_pk_bf16_f32 v74, v70, v71
  v_cvt_pk_bf16_f32 v75, v72, v73
  v_lshlrev_b32 v66, 16, v74
  v_and_b32 v67, 0xffff0000, v74
  v_lshlrev_b32 v68, 16, v75
  v_and_b32 v69, 0xffff0000, v75
  v_lshlrev_b32 v70, 16, v76
  v_and_b32 v71, 0xffff0000, v76
  v_lshlrev_b32 v72, 16, v77
  v_and_b32 v73, 0xffff0000, v77
  v_pk_mul_f32 v[66:67], v[66:67], v[70:71]
  v_pk_mul_f32 v[68:69], v[68:69], v[72:73]
  v_cvt_pk_bf16_f32 v96, v66, v67
  v_cvt_pk_bf16_f32 v97, v68, v69
  buffer_store_dwordx2 v[96:97], v98, s[48:51], s68 offen
  v_mov_b32 v24, 0
  v_mov_b32 v25, 0
  v_mov_b32 v26, 0
  v_mov_b32 v27, 0
  s_cmp_eq_u32 s57, 0
  s_cbranch_scc1 K1_nowait_3
  s_lshl_b32 s77, 1, s57
  s_sub_u32 s77, s77, 1
  s_mov_b32 s78, 0
  v_mov_b32 v21, 0
K1_poll_4:
  buffer_load_dword v20, v21, s[44:47], s76 offen sc1
  s_waitcnt vmcnt(0)
  v_readfirstlane_b32 s79, v20
  s_add_u32 s78, s78, 1
  s_and_b32 s79, s79, s77
  s_cmp_eq_u32 s79, s77
  s_cbranch_scc1 K1_got_5
  s_cmp_gt_u32 s78, 0x100000
  s_cbranch_scc1 K1_got_5
  s_sleep 2
  s_branch K1_poll_4
K1_got_5:
  s_mov_b32 s77, 0
  buffer_load_dwordx4 v[64:67], v39, s[40:43], s77 offen sc1
  s_cmp_le_u32 s57, 1
  s_cbranch_scc1 K1_aggld_6
  s_mov_b32 s77, 8192
  buffer_load_dwordx4 v[68:71], v39, s[40:43], s77 offen sc1
  s_cmp_le_u32 s57, 2
  s_cbranch_scc1 K1_aggld_6
  s_mov_b32 s77, 16384
  buffer_load_dwordx4 v[72:75], v39, s[40:43], s77 offen sc1
  s_cmp_le_u32 s57, 3
  s_cbranch_scc1 K1_aggld_6
  s_mov_b32 s77, 24576
  buffer_load_dwordx4 v[76:79], v39, s[40:43], s77 offen sc1
  s_cmp_le_u32 s57, 4
  s_cbranch_scc1 K1_aggld_6
  s_mov_b32 s77, 32768
  buffer_load_dwordx4 v[80:83], v39, s[40:43], s77 offen sc1
  s_cmp_le_u32 s57, 5
  s_cbranch_scc1 K1_aggld_6
  s_mov_b32 s77, 40960
  buffer_load_dwordx4 v[84:87], v39, s[40:43], s77 offen sc1
  s_cmp_le_u32 s57, 6
  s_cbranch_scc1 K1_aggld_6
  s_mov_b32 s77, 49152
  buffer_load_dwordx4 v[88:91], v39, s[40:43], s77 offen sc1
K1_aggld_6:
  s_waitcnt vmcnt(0)
  v_pk_fma_f32 v[20:21], v[24:25], v[14:15], v[64:65]
  v_pk_fma_f32 v[22:23], v[26:27], v[14:15], v[66:67]
  v_pk_fma_f32 v[20:21], v[26:27], v[18:19], v[20:21]
  v_pk_fma_f32 v[26:27], v[24:25], v[16:17], v[22:23]
  v_mov_b32 v24, v20
  v_mov_b32 v25, v21
  s_cmp_le_u32 s57, 1
  s_cbranch_scc1 K1_nowait_3
  v_pk_fma_f32 v[20:21], v[24:25], v[14:15], v[68:69]
  v_pk_fma_f32 v[22:23], v[26:27], v[14:15], v[70:71]
  v_pk_fma_f32 v[20:21], v[26:27], v[18:19], v[20:21]
  v_pk_fma_f32 v[26:27], v[24:25], v[16:17], v[22:23]
  v_mov_b32 v24, v20
  v_mov_b32 v25, v21
  s_cmp_le_u32 s57, 2
  s_cbranch_scc1 K1_nowait_3
  v_pk_fma_f32 v[20:21], v[24:25], v[14:15], v[72:73]
  v_pk_fma_f32 v[22:23], v[26:27], v[14:15], v[74:75]
  v_pk_fma_f32 v[20:21], v[26:27], v[18:19], v[20:21]
  v_pk_fma_f32 v[26:27], v[24:25], v[16:17], v[22:23]
  v_mov_b32 v24, v20
  v_mov_b32 v25, v21
  s_cmp_le_u32 s57, 3
  s_cbranch_scc1 K1_nowait_3
  v_pk_fma_f32 v[20:21], v[24:25], v[14:15], v[76:77]
  v_pk_fma_f32 v[22:23], v[26:27], v[14:15], v[78:79]
  v_pk_fma_f32 v[20:21], v[26:27], v[18:19], v[20:21]
  v_pk_fma_f32 v[26:27], v[24:25], v[16:17], v[22:23]
  v_mov_b32 v24, v20
  v_mov_b32 v25, v21
  s_cmp_le_u32 s57, 4
  s_cbranch_scc1 K1_nowait_3
  v_pk_fma_f32 v[20:21], v[24:25], v[14:15], v[80:81]
  v_pk_fma_f32 v[22:23], v[26:27], v[14:15], v[82:83]
  v_pk_fma_f32 v[20:21], v[26:27], v[18:19], v[20:21]
  v_pk_fma_f32 v[26:27], v[24:25], v[16:17], v[22:23]
  v_mov_b32 v24, v20
  v_mov_b32 v25, v21
  s_cmp_le_u32 s57, 5
  s_cbranch_scc1 K1_nowait_3
  v_pk_fma_f32 v[20:21], v[24:25], v[14:15], v[84:85]
  v_pk_fma_f32 v[22:23], v[26:27], v[14:15], v[86:87]
  v_pk_fma_f32 v[20:21], v[26:27], v[18:19], v[20:21]
  v_pk_fma_f32 v[26:27], v[24:25], v[16:17], v[22:23]
  v_mov_b32 v24, v20
  v_mov_b32 v25, v21
  s_cmp_le_u32 s57, 6
  s_cbranch_scc1 K1_nowait_3
  v_pk_fma_f32 v[20:21], v[24:25], v[14:15], v[88:89]
  v_pk_fma_f32 v[22:23], v[26:27], v[14:15], v[90:91]
  v_pk_fma_f32 v[20:21], v[26:27], v[18:19], v[20:21]
  v_pk_fma_f32 v[26:27], v[24:25], v[16:17], v[22:23]
  v_mov_b32 v24, v20
  v_mov_b32 v25, v21
K1_nowait_3:
  ds_read_b128 v[64:67], v63 offset:0
  ds_read_b128 v[68:71], v63 offset:256
  ds_read_b128 v[72:75], v63 offset:512
  ds_read_b128 v[76:79], v63 offset:768
  ds_read_b128 v[80:83], v63 offset:1024
  ds_read_b128 v[84:87], v63 offset:1280
  ds_read_b128 v[88:91], v63 offset:1536
  ds_read_b128 v[92:95], v63 offset:1792
  ds_read_b128 v[96:99], v63 offset:2048
  ds_read_b128 v[100:103], v63 offset:2304
  ds_read_b128 v[104:107], v63 offset:2560
  ds_read_b128 v[108:111], v63 offset:2816
  ds_read_b128 v[112:115], v63 offset:3072
  ds_read_b128 v[116:119], v63 offset:3328
  ds_read_b128 v[120:123], v63 offset:3584
  ds_read_b128 v[124:127], v63 offset:3840
  s_waitcnt lgkmcnt(0)
  v_cmp_eq_u32 vcc, 0, v34
  s_nop 1
  v_cndmask_b32 v28, v28, v24, vcc
  v_cndmask_b32 v29, v29, v25, vcc
  v_cndmask_b32 v30, v30, v26, vcc
  v_cndmask_b32 v31, v31, v27, vcc
  v_pk_fma_f32 v[20:21], v[24:25], v[8:9], v[64:65]
  v_pk_fma_f32 v[22:23], v[26:27], v[8:9], v[66:67]
  v_pk_fma_f32 v[20:21], v[26:27], v[12:13], v[20:21]
  v_pk_fma_f32 v[26:27], v[24:25], v[10:11], v[22:23]
  v_mov_b32 v24, v20
  v_mov_b32 v25, v21
  v_cmp_eq_u32 vcc, 1, v34
  s_nop 1
  v_cndmask_b32 v28, v28, v24, vcc
  v_cndmask_b32 v29, v29, v25, vcc
  v_cndmask_b32 v30, v30, v26, vcc
  v_cndmask_b32 v31, v31, v27, vcc
  v_pk_fma_f32 v[20:21], v[24:25], v[8:9], v[68:69]
  v_pk_fma_f32 v[22:23], v[26:27], v[8:9], v[70:71]
  v_pk_fma_f32 v[20:21], v[26:27], v[12:13], v[20:21]
  v_pk_fma_f32 v[26:27], v[24:25], v[10:11], v[22:23]
  v_mov_b32 v24, v20
  v_mov_b32 v25, v21
  v_cmp_eq_u32 vcc, 2, v34
  s_nop 1
  v_cndmask_b32 v28, v28, v24, vcc
  v_cndmask_b32 v29, v29, v25, vcc
  v_cndmask_b32 v30, v30, v26, vcc
  v_cndmask_b32 v31, v31, v27, vcc
  v_pk_fma_f32 v[20:21], v[24:25], v[8:9], v[72:73]
  v_pk_fma_f32 v[22:23], v[26:27], v[8:9], v[74:75]
  v_pk_fma_f32 v[20:21], v[26:27], v[12:13], v[20:21]
  v_pk_fma_f32 v[26:27], v[24:25], v[10:11], v[22:23]
  v_mov_b32 v24, v20
  v_mov_b32 v25, v21
  v_cmp_eq_u32 vcc, 3, v34
  s_nop 1
  v_cndmask_b32 v28, v28, v24, vcc
  v_cndmask_b32 v29, v29, v25, vcc
  v_cndmask_b32 v30, v30, v26, vcc
  v_cndmask_b32 v31, v31, v27, vcc
  v_pk_fma_f32 v[20:21], v[24:25], v[8:9], v[76:77]
  v_pk_fma_f32 v[22:23], v[26:27], v[8:9], v[78:79]
  v_pk_fma_f32 v[20:21], v[26:27], v[12:13], v[20:21]
  v_pk_fma_f32 v[26:27], v[24:25], v[10:11], v[22:23]
  v_mov_b32 v24, v20
  v_mov_b32 v25, v21
  v_cmp_eq_u32 vcc, 4, v34
  s_nop 1
  v_cndmask_b32 v28, v28, v24, vcc
  v_cndmask_b32 v29, v29, v25, vcc
  v_cndmask_b32 v30, v30, v26, vcc
  v_cndmask_b32 v31, v31, v27, vcc
  v_pk_fma_f32 v[20:21], v[24:25], v[8:9], v[80:81]
  v_pk_fma_f32 v[22:23], v[26:27], v[8:9], v[82:83]
  v_pk_fma_f32 v[20:21], v[26:27], v[12:13], v[20:21]
  v_pk_fma_f32 v[26:27], v[24:25], v[10:11], v[22:23]
  v_mov_b32 v24, v20
  v_mov_b32 v25, v21
  v_cmp_eq_u32 vcc, 5, v34
  s_nop 1
  v_cndmask_b32 v28, v28, v24, vcc
  v_cndmask_b32 v29, v29, v25, vcc
  v_cndmask_b32 v30, v30, v26, vcc
  v_cndmask_b32 v31, v31, v27, vcc
  v_pk_fma_f32 v[20:21], v[24:25], v[8:9], v[84:85]
  v_pk_fma_f32 v[22:23], v[26:27], v[8:9], v[86:87]
  v_pk_fma_f32 v[20:21], v[26:27], v[12:13], v[20:21]
  v_pk_fma_f32 v[26:27], v[24:25], v[10:11], v[22:23]
  v_mov_b32 v24, v20
  v_mov_b32 v25, v21
  v_cmp_eq_u32 vcc, 6, v34
  s_nop 1
  v_cndmask_b32 v28, v28, v24, vcc
  v_cndmask_b32 v29, v29, v25, vcc
  v_cndmask_b32 v30, v30, v26, vcc
  v_cndmask_b32 v31, v31, v27, vcc
  v_pk_fma_f32 v[20:21], v[24:25], v[8:9], v[88:89]
  v_pk_fma_f32 v[22:23], v[26:27], v[8:9], v[90:91]
  v_pk_fma_f32 v[20:21], v[26:27], v[12:13], v[20:21]
  v_pk_fma_f32 v[26:27], v[24:25], v[10:11], v[22:23]
  v_mov_b32 v24, v20
  v_mov_b32 v25, v21
  v_cmp_eq_u32 vcc, 7, v34
  s_nop 1
  v_cndmask_b32 v28, v28, v24, vcc
  v_cndmask_b32 v29, v29, v25, vcc
  v_cndmask_b32 v30, v30, v26, vcc
  v_cndmask_b32 v31, v31, v27, vcc
  v_pk_fma_f32 v[20:21], v[24:25], v[8:9], v[92:93]
  v_pk_fma_f32 v[22:23], v[26:27], v[8:9], v[94:95]
  v_pk_fma_f32 v[20:21], v[26:27], v[12:13], v[20:21]
  v_pk_fma_f32 v[26:27], v[24:25], v[10:11], v[22:23]
  v_mov_b32 v24, v20
  v_mov_b32 v25, v21
  v_cmp_eq_u32 vcc, 8, v34
  s_nop 1
  v_cndmask_b32 v28, v28, v24, vcc
  v_cndmask_b32 v29, v29, v25, vcc
  v_cndmask_b32 v30, v30, v26, vcc
  v_cndmask_b32 v31, v31, v27, vcc
  v_pk_fma_f32 v[20:21], v[24:25], v[8:9], v[96:97]
  v_pk_fma_f32 v[22:23], v[26:27], v[8:9], v[98:99]
  v_pk_fma_f32 v[20:21], v[26:27], v[12:13], v[20:21]
  v_pk_fma_f32 v[26:27], v[24:25], v[10:11], v[22:23]
  v_mov_b32 v24, v20
  v_mov_b32 v25, v21
  v_cmp_eq_u32 vcc, 9, v34
  s_nop 1
  v_cndmask_b32 v28, v28, v24, vcc
  v_cndmask_b32 v29, v29, v25, vcc
  v_cndmask_b32 v30, v30, v26, vcc
  v_cndmask_b32 v31, v31, v27, vcc
  v_pk_fma_f32 v[20:21], v[24:25], v[8:9], v[100:101]
  v_pk_fma_f32 v[22:23], v[26:27], v[8:9], v[102:103]
  v_pk_fma_f32 v[20:21], v[26:27], v[12:13], v[20:21]
  v_pk_fma_f32 v[26:27], v[24:25], v[10:11], v[22:23]
  v_mov_b32 v24, v20
  v_mov_b32 v25, v21
  v_cmp_eq_u32 vcc, 10, v34
  s_nop 1
  v_cndmask_b32 v28, v28, v24, vcc
  v_cndmask_b32 v29, v29, v25, vcc
  v_cndmask_b32 v30, v30, v26, vcc
  v_cndmask_b32 v31, v31, v27, vcc
  v_pk_fma_f32 v[20:21], v[24:25], v[8:9], v[104:105]
  v_pk_fma_f32 v[22:23], v[26:27], v[8:9], v[106:107]
  v_pk_fma_f32 v[20:21], v[26:27], v[12:13], v[20:21]
  v_pk_fma_f32 v[26:27], v[24:25], v[10:11], v[22:23]
  v_mov_b32 v24, v20
  v_mov_b32 v25, v21
  v_cmp_eq_u32 vcc, 11, v34
  s_nop 1
  v_cndmask_b32 v28, v28, v24, vcc
  v_cndmask_b32 v29, v29, v25, vcc
  v_cndmask_b32 v30, v30, v26, vcc
  v_cndmask_b32 v31, v31, v27, vcc
  v_pk_fma_f32 v[20:21], v[24:25], v[8:9], v[108:109]
  v_pk_fma_f32 v[22:23], v[26:27], v[8:9], v[110:111]
  v_pk_fma_f32 v[20:21], v[26:27], v[12:13], v[20:21]
  v_pk_fma_f32 v[26:27], v[24:25], v[10:11], v[22:23]
  v_mov_b32 v24, v20
  v_mov_b32 v25, v21
  v_cmp_eq_u32 vcc, 12, v34
  s_nop 1
  v_cndmask_b32 v28, v28, v24, vcc
  v_cndmask_b32 v29, v29, v25, vcc
  v_cndmask_b32 v30, v30, v26, vcc
  v_cndmask_b32 v31, v31, v27, vcc
  v_pk_fma_f32 v[20:21], v[24:25], v[8:9], v[112:113]
  v_pk_fma_f32 v[22:23], v[26:27], v[8:9], v[114:115]
  v_pk_fma_f32 v[20:21], v[26:27], v[12:13], v[20:21]
  v_pk_fma_f32 v[26:27], v[24:25], v[10:11], v[22:23]
  v_mov_b32 v24, v20
  v_mov_b32 v25, v21
  v_cmp_eq_u32 vcc, 13, v34
  s_nop 1
  v_cndmask_b32 v28, v28, v24, vcc
  v_cndmask_b32 v29, v29, v25, vcc
  v_cndmask_b32 v30, v30, v26, vcc
  v_cndmask_b32 v31, v31, v27, vcc
  v_pk_fma_f32 v[20:21], v[24:25], v[8:9], v[116:117]
  v_pk_fma_f32 v[22:23], v[26:27], v[8:9], v[118:119]
  v_pk_fma_f32 v[20:21], v[26:27], v[12:13], v[20:21]
  v_pk_fma_f32 v[26:27], v[24:25], v[10:11], v[22:23]
  v_mov_b32 v24, v20
  v_mov_b32 v25, v21
  v_cmp_eq_u32 vcc, 14, v34
  s_nop 1
  v_cndmask_b32 v28, v28, v24, vcc
  v_cndmask_b32 v29, v29, v25, vcc
  v_cndmask_b32 v30, v30, v26, vcc
  v_cndmask_b32 v31, v31, v27, vcc
  v_pk_fma_f32 v[20:21], v[24:25], v[8:9], v[120:121]
  v_pk_fma_f32 v[22:23], v[26:27], v[8:9], v[122:123]
  v_pk_fma_f32 v[20:21], v[26:27], v[12:13], v[20:21]
  v_pk_fma_f32 v[26:27], v[24:25], v[10:11], v[22:23]
  v_mov_b32 v24, v20
  v_mov_b32 v25, v21
  v_cmp_eq_u32 vcc, 15, v34
  s_nop 1
  v_cndmask_b32 v28, v28, v24, vcc
  v_cndmask_b32 v29, v29, v25, vcc
  v_cndmask_b32 v30, v30, v26, vcc
  v_cndmask_b32 v31, v31, v27, vcc
  v_pk_fma_f32 v[20:21], v[24:25], v[8:9], v[124:125]
  v_pk_fma_f32 v[22:23], v[26:27], v[8:9], v[126:127]
  v_pk_fma_f32 v[20:21], v[26:27], v[12:13], v[20:21]
  v_pk_fma_f32 v[26:27], v[24:25], v[10:11], v[22:23]
  v_mov_b32 v24, v20
  v_mov_b32 v25, v21
  ds_read_b64 v[64:65], v62 offset:0
  ds_read_b64 v[66:67], v62 offset:128
  ds_read_b64 v[68:69], v62 offset:272
  ds_read_b64 v[70:71], v62 offset:400
  ds_read_b64 v[72:73], v62 offset:544
  ds_read_b64 v[74:75], v62 offset:672
  ds_read_b64 v[76:77], v62 offset:816
  ds_read_b64 v[78:79], v62 offset:944
  ds_read_b64 v[80:81], v62 offset:1088
  ds_read_b64 v[82:83], v62 offset:1216
  ds_read_b64 v[84:85], v62 offset:1360
  ds_read_b64 v[86:87], v62 offset:1488
  ds_read_b64 v[88:89], v62 offset:1632
  ds_read_b64 v[90:91], v62 offset:1760
  ds_read_b64 v[92:93], v62 offset:1904
  ds_read_b64 v[94:95], v62 offset:2032
  ds_read_b64 v[96:97], v62 offset:2176
  ds_read_b64 v[98:99], v62 offset:2304
  ds_read_b64 v[100:101], v62 offset:2448
  ds_read_b64 v[102:103], v62 offset:2576
  ds_read_b64 v[104:105], v62 offset:2720
  ds_read_b64 v[106:107], v62 offset:2848
  ds_read_b64 v[108:109], v62 offset:2992
  ds_read_b64 v[110:111], v62 offset:3120
  ds_read_b64 v[112:113], v62 offset:3264
  ds_read_b64 v[114:115], v62 offset:3392
  ds_read_b64 v[116:117], v62 offset:3536
  ds_read_b64 v[118:119], v62 offset:3664
  ds_read_b64 v[120:121], v62 offset:3808
  ds_read_b64 v[122:123], v62 offset:3936
  ds_read_b64 v[124:125], v62 offset:4080
  ds_read_b64 v[126:127], v62 offset:4208
  v_mov_b32 v24, v28
  v_mov_b32 v25, v29
  v_mov_b32 v26, v30
  v_mov_b32 v27, v31
  s_add_u32 s48, s36, 0x1000000
  s_addc_u32 s49, s37, 0
  s_mov_b32 s50, 0x800000
  s_mov_b32 s51, 0x00020000
  s_add_u32 s52, s36, 0x1800000
  s_addc_u32 s53, s37, 0
  s_mov_b32 s54, 0x800000
  s_mov_b32 s55, 0x00020000
  s_lshl_b32 s74, s57, 20
  s_lshr_b32 s77, s58, 1
  s_lshl_b32 s77, s77, 14
  s_add_u32 s74, s74, s77
  s_and_b32 s77, s58, 1
  s_lshl_b32 s77, s77, 6
  s_add_u32 s74, s74, s77
  v_lshrrev_b32 v39, 3, v34
  v_lshlrev_b32 v39, 19, v39
  v_and_b32 v28, 7, v34
  v_lshl_add_u32 v39, v28, 11, v39
  v_lshl_add_u32 v39, v3, 2, v39
  v_add_u32 v39, s74, v39
  s_waitcnt lgkmcnt(0)
  v_pk_fma_f32 v[20:21], v[24:25], v[50:51], v[64:65]
  v_pk_fma_f32 v[22:23], v[26:27], v[50:51], v[66:67]
  v_pk_fma_f32 v[20:21], v[26:27], v[58:59], v[20:21]
  v_pk_fma_f32 v[26:27], v[24:25], v[52:53], v[22:23]
  v_mov_b32 v24, v20
  v_mov_b32 v25, v21
  v_cvt_pk_bf16_f32 v240, v24, v25
  v_cvt_pk_bf16_f32 v242, -v26, -v27
  v_lshlrev_b32 v28, 16, v240
  v_and_b32 v29, 0xffff0000, v240
  v_lshlrev_b32 v30, 16, v242
  v_and_b32 v31, 0xffff0000, v242
  v_sub_f32 v28, v24, v28
  v_sub_f32 v29, v25, v29
  v_sub_f32_e64 v30, -v26, v30
  v_sub_f32_e64 v31, -v27, v31
  v_cvt_pk_bf16_f32 v241, v28, v29
  v_cvt_pk_bf16_f32 v243, v30, v31
  s_mov_b32 s74, 262144
  buffer_store_dword v240, v39, s[48:51], 0 offen offset:0
  buffer_store_dword v242, v39, s[48:51], s74 offen offset:0
  buffer_store_dword v241, v39, s[52:55], 0 offen offset:0
  buffer_store_dword v243, v39, s[52:55], s74 offen offset:0
  v_pk_fma_f32 v[20:21], v[24:25], v[50:51], v[68:69]
  v_pk_fma_f32 v[22:23], v[26:27], v[50:51], v[70:71]
  v_pk_fma_f32 v[20:21], v[26:27], v[58:59], v[20:21]
  v_pk_fma_f32 v[26:27], v[24:25], v[52:53], v[22:23]
  v_mov_b32 v24, v20
  v_mov_b32 v25, v21
  v_cvt_pk_bf16_f32 v244, v24, v25
  v_cvt_pk_bf16_f32 v246, -v26, -v27
  v_lshlrev_b32 v28, 16, v244
  v_and_b32 v29, 0xffff0000, v244
  v_lshlrev_b32 v30, 16, v246
  v_and_b32 v31, 0xffff0000, v246
  v_sub_f32 v28, v24, v28
  v_sub_f32 v29, v25, v29
  v_sub_f32_e64 v30, -v26, v30
  v_sub_f32_e64 v31, -v27, v31
  v_cvt_pk_bf16_f32 v245, v28, v29
  v_cvt_pk_bf16_f32 v247, v30, v31
  s_mov_b32 s74, 262144
  buffer_store_dword v244, v39, s[48:51], 0 offen offset:128
  buffer_store_dword v246, v39, s[48:51], s74 offen offset:128
  buffer_store_dword v245, v39, s[52:55], 0 offen offset:128
  buffer_store_dword v247, v39, s[52:55], s74 offen offset:128
  v_pk_fma_f32 v[20:21], v[24:25], v[50:51], v[72:73]
  v_pk_fma_f32 v[22:23], v[26:27], v[50:51], v[74:75]
  v_pk_fma_f32 v[20:21], v[26:27], v[58:59], v[20:21]
  v_pk_fma_f32 v[26:27], v[24:25], v[52:53], v[22:23]
  v_mov_b32 v24, v20
  v_mov_b32 v25, v21
  v_cvt_pk_bf16_f32 v248, v24, v25
  v_cvt_pk_bf16_f32 v250, -v26, -v27
  v_lshlrev_b32 v28, 16, v248
  v_and_b32 v29, 0xffff0000, v248
  v_lshlrev_b32 v30, 16, v250
  v_and_b32 v31, 0xffff0000, v250
  v_sub_f32 v28, v24, v28
  v_sub_f32 v29, v25, v29
  v_sub_f32_e64 v30, -v26, v30
  v_sub_f32_e64 v31, -v27, v31
  v_cvt_pk_bf16_f32 v249, v28, v29
  v_cvt_pk_bf16_f32 v251, v30, v31
  s_mov_b32 s74, 262144
  buffer_store_dword v248, v39, s[48:51], 0 offen offset:256
  buffer_store_dword v250, v39, s[48:51], s74 offen offset:256
  buffer_store_dword v249, v39, s[52:55], 0 offen offset:256
  buffer_store_dword v251, v39, s[52:55], s74 offen offset:256
  v_pk_fma_f32 v[20:21], v[24:25], v[50:51], v[76:77]
  v_pk_fma_f32 v[22:23], v[26:27], v[50:51], v[78:79]
  v_pk_fma_f32 v[20:21], v[26:27], v[58:59], v[20:21]
  v_pk_fma_f32 v[26:27], v[24:25], v[52:53], v[22:23]
  v_mov_b32 v24, v20
  v_mov_b32 v25, v21
  v_cvt_pk_bf16_f32 v252, v24, v25
  v_cvt_pk_bf16_f32 v254, -v26, -v27
  v_lshlrev_b32 v28, 16, v252
  v_and_b32 v29, 0xffff0000, v252
  v_lshlrev_b32 v30, 16, v254
  v_and_b32 v31, 0xffff0000, v254
  v_sub_f32 v28, v24, v28
  v_sub_f32 v29, v25, v29
  v_sub_f32_e64 v30, -v26, v30
  v_sub_f32_e64 v31, -v27, v31
  v_cvt_pk_bf16_f32 v253, v28, v29
  v_cvt_pk_bf16_f32 v255, v30, v31
  s_mov_b32 s74, 262144
  buffer_store_dword v252, v39, s[48:51], 0 offen offset:384
  buffer_store_dword v254, v39, s[48:51], s74 offen offset:384
  buffer_store_dword v253, v39, s[52:55], 0 offen offset:384
  buffer_store_dword v255, v39, s[52:55], s74 offen offset:384
  v_pk_fma_f32 v[20:21], v[24:25], v[50:51], v[80:81]
  v_pk_fma_f32 v[22:23], v[26:27], v[50:51], v[82:83]
  v_pk_fma_f32 v[20:21], v[26:27], v[58:59], v[20:21]
  v_pk_fma_f32 v[26:27], v[24:25], v[52:53], v[22:23]
  v_mov_b32 v24, v20
  v_mov_b32 v25, v21
  v_cvt_pk_bf16_f32 v240, v24, v25
  v_cvt_pk_bf16_f32 v242, -v26, -v27
  v_lshlrev_b32 v28, 16, v240
  v_and_b32 v29, 0xffff0000, v240
  v_lshlrev_b32 v30, 16, v242
  v_and_b32 v31, 0xffff0000, v242
  v_sub_f32 v28, v24, v28
  v_sub_f32 v29, v25, v29
  v_sub_f32_e64 v30, -v26, v30
  v_sub_f32_e64 v31, -v27, v31
  v_cvt_pk_bf16_f32 v241, v28, v29
  v_cvt_pk_bf16_f32 v243, v30, v31
  s_mov_b32 s74, 262144
  buffer_store_dword v240, v39, s[48:51], 0 offen offset:512
  buffer_store_dword v242, v39, s[48:51], s74 offen offset:512
  buffer_store_dword v241, v39, s[52:55], 0 offen offset:512
  buffer_store_dword v243, v39, s[52:55], s74 offen offset:512
  v_pk_fma_f32 v[20:21], v[24:25], v[50:51], v[84:85]
  v_pk_fma_f32 v[22:23], v[26:27], v[50:51], v[86:87]
  v_pk_fma_f32 v[20:21], v[26:27], v[58:59], v[20:21]
  v_pk_fma_f32 v[26:27], v[24:25], v[52:53], v[22:23]
  v_mov_b32 v24, v20
  v_mov_b32 v25, v21
  v_cvt_pk_bf16_f32 v244, v24, v25
  v_cvt_pk_bf16_f32 v246, -v26, -v27
  v_lshlrev_b32 v28, 16, v244
  v_and_b32 v29, 0xffff0000, v244
  v_lshlrev_b32 v30, 16, v246
  v_and_b32 v31, 0xffff0000, v246
  v_sub_f32 v28, v24, v28
  v_sub_f32 v29, v25, v29
  v_sub_f32_e64 v30, -v26, v30
  v_sub_f32_e64 v31, -v27, v31
  v_cvt_pk_bf16_f32 v245, v28, v29
  v_cvt_pk_bf16_f32 v247, v30, v31
  s_mov_b32 s74, 262144
  buffer_store_dword v244, v39, s[48:51], 0 offen offset:640
  buffer_store_dword v246, v39, s[48:51], s74 offen offset:640
  buffer_store_dword v245, v39, s[52:55], 0 offen offset:640
  buffer_store_dword v247, v39, s[52:55], s74 offen offset:640
  v_pk_fma_f32 v[20:21], v[24:25], v[50:51], v[88:89]
  v_pk_fma_f32 v[22:23], v[26:27], v[50:51], v[90:91]
  v_pk_fma_f32 v[20:21], v[26:27], v[58:59], v[20:21]
  v_pk_fma_f32 v[26:27], v[24:25], v[52:53], v[22:23]
  v_mov_b32 v24, v20
  v_mov_b32 v25, v21
  v_cvt_pk_bf16_f32 v248, v24, v25
  v_cvt_pk_bf16_f32 v250, -v26, -v27
  v_lshlrev_b32 v28, 16, v248
  v_and_b32 v29, 0xffff0000, v248
  v_lshlrev_b32 v30, 16, v250
  v_and_b32 v31, 0xffff0000, v250
  v_sub_f32 v28, v24, v28
  v_sub_f32 v29, v25, v29
  v_sub_f32_e64 v30, -v26, v30
  v_sub_f32_e64 v31, -v27, v31
  v_cvt_pk_bf16_f32 v249, v28, v29
  v_cvt_pk_bf16_f32 v251, v30, v31
  s_mov_b32 s74, 262144
  buffer_store_dword v248, v39, s[48:51], 0 offen offset:768
  buffer_store_dword v250, v39, s[48:51], s74 offen offset:768
  buffer_store_dword v249, v39, s[52:55], 0 offen offset:768
  buffer_store_dword v251, v39, s[52:55], s74 offen offset:768
  v_pk_fma_f32 v[20:21], v[24:25], v[50:51], v[92:93]
  v_pk_fma_f32 v[22:23], v[26:27], v[50:51], v[94:95]
  v_pk_fma_f32 v[20:21], v[26:27], v[58:59], v[20:21]
  v_pk_fma_f32 v[26:27], v[24:25], v[52:53], v[22:23]
  v_mov_b32 v24, v20
  v_mov_b32 v25, v21
  v_cvt_pk_bf16_f32 v252, v24, v25
  v_cvt_pk_bf16_f32 v254, -v26, -v27
  v_lshlrev_b32 v28, 16, v252
  v_and_b32 v29, 0xffff0000, v252
  v_lshlrev_b32 v30, 16, v254
  v_and_b32 v31, 0xffff0000, v254
  v_sub_f32 v28, v24, v28
  v_sub_f32 v29, v25, v29
  v_sub_f32_e64 v30, -v26, v30
  v_sub_f32_e64 v31, -v27, v31
  v_cvt_pk_bf16_f32 v253, v28, v29
  v_cvt_pk_bf16_f32 v255, v30, v31
  s_mov_b32 s74, 262144
  buffer_store_dword v252, v39, s[48:51], 0 offen offset:896
  buffer_store_dword v254, v39, s[48:51], s74 offen offset:896
  buffer_store_dword v253, v39, s[52:55], 0 offen offset:896
  buffer_store_dword v255, v39, s[52:55], s74 offen offset:896
  v_pk_fma_f32 v[20:21], v[24:25], v[50:51], v[96:97]
  v_pk_fma_f32 v[22:23], v[26:27], v[50:51], v[98:99]
  v_pk_fma_f32 v[20:21], v[26:27], v[58:59], v[20:21]
  v_pk_fma_f32 v[26:27], v[24:25], v[52:53], v[22:23]
  v_mov_b32 v24, v20
  v_mov_b32 v25, v21
  v_cvt_pk_bf16_f32 v240, v24, v25
  v_cvt_pk_bf16_f32 v242, -v26, -v27
  v_lshlrev_b32 v28, 16, v240
  v_and_b32 v29, 0xffff0000, v240
  v_lshlrev_b32 v30, 16, v242
  v_and_b32 v31, 0xffff0000, v242
  v_sub_f32 v28, v24, v28
  v_sub_f32 v29, v25, v29
  v_sub_f32_e64 v30, -v26, v30
  v_sub_f32_e64 v31, -v27, v31
  v_cvt_pk_bf16_f32 v241, v28, v29
  v_cvt_pk_bf16_f32 v243, v30, v31
  s_mov_b32 s74, 262144
  buffer_store_dword v240, v39, s[48:51], 0 offen offset:1024
  buffer_store_dword v242, v39, s[48:51], s74 offen offset:1024
  buffer_store_dword v241, v39, s[52:55], 0 offen offset:1024
  buffer_store_dword v243, v39, s[52:55], s74 offen offset:1024
  v_pk_fma_f32 v[20:21], v[24:25], v[50:51], v[100:101]
  v_pk_fma_f32 v[22:23], v[26:27], v[50:51], v[102:103]
  v_pk_fma_f32 v[20:21], v[26:27], v[58:59], v[20:21]
  v_pk_fma_f32 v[26:27], v[24:25], v[52:53], v[22:23]
  v_mov_b32 v24, v20
  v_mov_b32 v25, v21
  v_cvt_pk_bf16_f32 v244, v24, v25
  v_cvt_pk_bf16_f32 v246, -v26, -v27
  v_lshlrev_b32 v28, 16, v244
  v_and_b32 v29, 0xffff0000, v244
  v_lshlrev_b32 v30, 16, v246
  v_and_b32 v31, 0xffff0000, v246
  v_sub_f32 v28, v24, v28
  v_sub_f32 v29, v25, v29
  v_sub_f32_e64 v30, -v26, v30
  v_sub_f32_e64 v31, -v27, v31
  v_cvt_pk_bf16_f32 v245, v28, v29
  v_cvt_pk_bf16_f32 v247, v30, v31
  s_mov_b32 s74, 262144
  buffer_store_dword v244, v39, s[48:51], 0 offen offset:1152
  buffer_store_dword v246, v39, s[48:51], s74 offen offset:1152
  buffer_store_dword v245, v39, s[52:55], 0 offen offset:1152
  buffer_store_dword v247, v39, s[52:55], s74 offen offset:1152
  v_pk_fma_f32 v[20:21], v[24:25], v[50:51], v[104:105]
  v_pk_fma_f32 v[22:23], v[26:27], v[50:51], v[106:107]
  v_pk_fma_f32 v[20:21], v[26:27], v[58:59], v[20:21]
  v_pk_fma_f32 v[26:27], v[24:25], v[52:53], v[22:23]
  v_mov_b32 v24, v20
  v_mov_b32 v25, v21
  v_cvt_pk_bf16_f32 v248, v24, v25
  v_cvt_pk_bf16_f32 v250, -v26, -v27
  v_lshlrev_b32 v28, 16, v248
  v_and_b32 v29, 0xffff0000, v248
  v_lshlrev_b32 v30, 16, v250
  v_and_b32 v31, 0xffff0000, v250
  v_sub_f32 v28, v24, v28
  v_sub_f32 v29, v25, v29
  v_sub_f32_e64 v30, -v26, v30
  v_sub_f32_e64 v31, -v27, v31
  v_cvt_pk_bf16_f32 v249, v28, v29
  v_cvt_pk_bf16_f32 v251, v30, v31
  s_mov_b32 s74, 262144
  buffer_store_dword v248, v39, s[48:51], 0 offen offset:1280
  buffer_store_dword v250, v39, s[48:51], s74 offen offset:1280
  buffer_store_dword v249, v39, s[52:55], 0 offen offset:1280
  buffer_store_dword v251, v39, s[52:55], s74 offen offset:1280
  v_pk_fma_f32 v[20:21], v[24:25], v[50:51], v[108:109]
  v_pk_fma_f32 v[22:23], v[26:27], v[50:51], v[110:111]
  v_pk_fma_f32 v[20:21], v[26:27], v[58:59], v[20:21]
  v_pk_fma_f32 v[26:27], v[24:25], v[52:53], v[22:23]
  v_mov_b32 v24, v20
  v_mov_b32 v25, v21
  v_cvt_pk_bf16_f32 v252, v24, v25
  v_cvt_pk_bf16_f32 v254, -v26, -v27
  v_lshlrev_b32 v28, 16, v252
  v_and_b32 v29, 0xffff0000, v252
  v_lshlrev_b32 v30, 16, v254
  v_and_b32 v31, 0xffff0000, v254
  v_sub_f32 v28, v24, v28
  v_sub_f32 v29, v25, v29
  v_sub_f32_e64 v30, -v26, v30
  v_sub_f32_e64 v31, -v27, v31
  v_cvt_pk_bf16_f32 v253, v28, v29
  v_cvt_pk_bf16_f32 v255, v30, v31
  s_mov_b32 s74, 262144
  buffer_store_dword v252, v39, s[48:51], 0 offen offset:1408
  buffer_store_dword v254, v39, s[48:51], s74 offen offset:1408
  buffer_store_dword v253, v39, s[52:55], 0 offen offset:1408
  buffer_store_dword v255, v39, s[52:55], s74 offen offset:1408
  v_pk_fma_f32 v[20:21], v[24:25], v[50:51], v[112:113]
  v_pk_fma_f32 v[22:23], v[26:27], v[50:51], v[114:115]
  v_pk_fma_f32 v[20:21], v[26:27], v[58:59], v[20:21]
  v_pk_fma_f32 v[26:27], v[24:25], v[52:53], v[22:23]
  v_mov_b32 v24, v20
  v_mov_b32 v25, v21
  v_cvt_pk_bf16_f32 v240, v24, v25
  v_cvt_pk_bf16_f32 v242, -v26, -v27
  v_lshlrev_b32 v28, 16, v240
  v_and_b32 v29, 0xffff0000, v240
  v_lshlrev_b32 v30, 16, v242
  v_and_b32 v31, 0xffff0000, v242
  v_sub_f32 v28, v24, v28
  v_sub_f32 v29, v25, v29
  v_sub_f32_e64 v30, -v26, v30
  v_sub_f32_e64 v31, -v27, v31
  v_cvt_pk_bf16_f32 v241, v28, v29
  v_cvt_pk_bf16_f32 v243, v30, v31
  s_mov_b32 s74, 262144
  buffer_store_dword v240, v39, s[48:51], 0 offen offset:1536
  buffer_store_dword v242, v39, s[48:51], s74 offen offset:1536
  buffer_store_dword v241, v39, s[52:55], 0 offen offset:1536
  buffer_store_dword v243, v39, s[52:55], s74 offen offset:1536
  v_pk_fma_f32 v[20:21], v[24:25], v[50:51], v[116:117]
  v_pk_fma_f32 v[22:23], v[26:27], v[50:51], v[118:119]
  v_pk_fma_f32 v[20:21], v[26:27], v[58:59], v[20:21]
  v_pk_fma_f32 v[26:27], v[24:25], v[52:53], v[22:23]
  v_mov_b32 v24, v20
  v_mov_b32 v25, v21
  v_cvt_pk_bf16_f32 v244, v24, v25
  v_cvt_pk_bf16_f32 v246, -v26, -v27
  v_lshlrev_b32 v28, 16, v244
  v_and_b32 v29, 0xffff0000, v244
  v_lshlrev_b32 v30, 16, v246
  v_and_b32 v31, 0xffff0000, v246
  v_sub_f32 v28, v24, v28
  v_sub_f32 v29, v25, v29
  v_sub_f32_e64 v30, -v26, v30
  v_sub_f32_e64 v31, -v27, v31
  v_cvt_pk_bf16_f32 v245, v28, v29
  v_cvt_pk_bf16_f32 v247, v30, v31
  s_mov_b32 s74, 262144
  buffer_store_dword v244, v39, s[48:51], 0 offen offset:1664
  buffer_store_dword v246, v39, s[48:51], s74 offen offset:1664
  buffer_store_dword v245, v39, s[52:55], 0 offen offset:1664
  buffer_store_dword v247, v39, s[52:55], s74 offen offset:1664
  v_pk_fma_f32 v[20:21], v[24:25], v[50:51], v[120:121]
  v_pk_fma_f32 v[22:23], v[26:27], v[50:51], v[122:123]
  v_pk_fma_f32 v[20:21], v[26:27], v[58:59], v[20:21]
  v_pk_fma_f32 v[26:27], v[24:25], v[52:53], v[22:23]
  v_mov_b32 v24, v20
  v_mov_b32 v25, v21
  v_cvt_pk_bf16_f32 v248, v24, v25
  v_cvt_pk_bf16_f32 v250, -v26, -v27
  v_lshlrev_b32 v28, 16, v248
  v_and_b32 v29, 0xffff0000, v248
  v_lshlrev_b32 v30, 16, v250
  v_and_b32 v31, 0xffff0000, v250
  v_sub_f32 v28, v24, v28
  v_sub_f32 v29, v25, v29
  v_sub_f32_e64 v30, -v26, v30
  v_sub_f32_e64 v31, -v27, v31
  v_cvt_pk_bf16_f32 v249, v28, v29
  v_cvt_pk_bf16_f32 v251, v30, v31
  s_mov_b32 s74, 262144
  buffer_store_dword v248, v39, s[48:51], 0 offen offset:1792
  buffer_store_dword v250, v39, s[48:51], s74 offen offset:1792
  buffer_store_dword v249, v39, s[52:55], 0 offen offset:1792
  buffer_store_dword v251, v39, s[52:55], s74 offen offset:1792
  v_pk_fma_f32 v[20:21], v[24:25], v[50:51], v[124:125]
  v_pk_fma_f32 v[22:23], v[26:27], v[50:51], v[126:127]
  v_pk_fma_f32 v[20:21], v[26:27], v[58:59], v[20:21]
  v_pk_fma_f32 v[26:27], v[24:25], v[52:53], v[22:23]
  v_mov_b32 v24, v20
  v_mov_b32 v25, v21
  v_cvt_pk_bf16_f32 v252, v24, v25
  v_cvt_pk_bf16_f32 v254, -v26, -v27
  v_lshlrev_b32 v28, 16, v252
  v_and_b32 v29, 0xffff0000, v252
  v_lshlrev_b32 v30, 16, v254
  v_and_b32 v31, 0xffff0000, v254
  v_sub_f32 v28, v24, v28
  v_sub_f32 v29, v25, v29
  v_sub_f32_e64 v30, -v26, v30
  v_sub_f32_e64 v31, -v27, v31
  v_cvt_pk_bf16_f32 v253, v28, v29
  v_cvt_pk_bf16_f32 v255, v30, v31
  s_mov_b32 s74, 262144
  buffer_store_dword v252, v39, s[48:51], 0 offen offset:1920
  buffer_store_dword v254, v39, s[48:51], s74 offen offset:1920
  buffer_store_dword v253, v39, s[52:55], 0 offen offset:1920
  buffer_store_dword v255, v39, s[52:55], s74 offen offset:1920
K1_end:
  s_endpgm
.globl gm_phase2_kernel
.p2align 8
.type gm_phase2_kernel,@function
gm_phase2_kernel:
  s_cmp_ge_u32 s2, 256
  s_cbranch_scc1 K2_end
  s_load_dwordx16 s[4:19], s[0:1], 0
  s_load_dwordx16 s[20:35], s[0:1], 64
  s_load_dwordx2 s[36:37], s[0:1], 128
  v_and_b32 v1, 63, v0
  v_lshrrev_b32 v2, 6, v0
  s_nop 0
  v_readfirstlane_b32 s56, v2
  v_and_b32 v3, 15, v1
  v_lshrrev_b32 v4, 4, v1
  s_and_b32 s61, s2, 3
  s_lshr_b32 s62, s2, 3
  s_lshl_b32 s57, s61, 2
  s_lshr_b32 s63, s62, 3
  s_add_u32 s57, s57, s63
  s_and_b32 s58, s62, 7
  s_lshl_b32 s60, s57, 3
  s_add_u32 s60, s60, s58
  s_lshr_b32 s87, s56, 1
  s_and_b32 s88, s56, 1
  s_lshl_b32 s70, s56, 12
  s_waitcnt lgkmcnt(0)
  v_and_b32 v32, 7, v1
  v_xor_b32 v32, v32, v4
  v_lshlrev_b32 v32, 4, v32
  v_lshl_add_u32 v32, v3, 7, v32
  s_lshl_b32 s74, s87, 13
  v_add_u32 v20, s74, v32
  v_xor_b32 v21, 64, v20
  v_mov_b32 v31, v32
  v_mov_b32 v64, 0
  v_mov_b32 v65, 0
  v_mov_b32 v66, 0
  v_mov_b32 v67, 0
  v_mov_b32 v68, 0
  v_mov_b32 v69, 0
  v_mov_b32 v70, 0
  v_mov_b32 v71, 0
  v_mov_b32 v72, 0
  v_mov_b32 v73, 0
  v_mov_b32 v74, 0
  v_mov_b32 v75, 0
  v_mov_b32 v76, 0
  v_mov_b32 v77, 0
  v_mov_b32 v78, 0
  v_mov_b32 v79, 0
  v_mov_b32 v80, 0
  v_mov_b32 v81, 0
  v_mov_b32 v82, 0
  v_mov_b32 v83, 0
  v_mov_b32 v84, 0
  v_mov_b32 v85, 0
  v_mov_b32 v86, 0
  v_mov_b32 v87, 0
  v_mov_b32 v88, 0
  v_mov_b32 v89, 0
  v_mov_b32 v90, 0
  v_mov_b32 v91, 0
  v_mov_b32 v92, 0
  v_mov_b32 v93, 0
  v_mov_b32 v94, 0
  v_mov_b32 v95, 0
  v_mov_b32 v96, 0
  v_mov_b32 v97, 0
  v_mov_b32 v98, 0
  v_mov_b32 v99, 0
  v_mov_b32 v100, 0
  v_mov_b32 v101, 0
  v_mov_b32 v102, 0
  v_mov_b32 v103, 0
  v_mov_b32 v104, 0
  v_mov_b32 v105, 0
  v_mov_b32 v106, 0
  v_mov_b32 v107, 0
  v_mov_b32 v108, 0
  v_mov_b32 v109, 0
  v_mov_b32 v110, 0
  v_mov_b32 v111, 0
  v_mov_b32 v112, 0
  v_mov_b32 v113, 0
  v_mov_b32 v114, 0
  v_mov_b32 v115, 0
  v_mov_b32 v116, 0
  v_mov_b32 v117, 0
  v_mov_b32 v118, 0
  v_mov_b32 v119, 0
  v_mov_b32 v120, 0
  v_mov_b32 v121, 0
  v_mov_b32 v122, 0
  v_mov_b32 v123, 0
  v_mov_b32 v124, 0
  v_mov_b32 v125, 0
  v_mov_b32 v126, 0
  v_mov_b32 v127, 0
  s_mov_b32 s62, 0
  s_mov_b32 s63, 0
  s_mov_b32 s64, 0
  s_mov_b32 s65, 0
  s_mov_b32 s71, 0
  s_bitcmp1_b32 s2, 2
  s_cbranch_scc1 K2_typeB
  s_mov_b32 s40, s36
  s_mov_b32 s41, s37
  s_mov_b32 s42, 0xe00000
  s_mov_b32 s43, 0x00020000
  s_mov_b32 s44, s28
  s_mov_b32 s45, s29
  s_mov_b32 s46, 0x700000
  s_mov_b32 s47, 0x00020000
  s_mul_i32 s73, s57, 917504
  s_lshl_b32 s75, s58, 8
  s_lshl_b32 s74, s56, 8
  s_add_u32 s74, s74, 0
  v_add_u32 v32, s74, v1
  v_lshrrev_b32 v33, 3, v32
  v_and_b32 v34, 7, v32
  v_and_b32 v35, 7, v33
  v_xor_b32 v34, v34, v35
  v_lshlrev_b32 v35, 7, v33
  v_lshl_add_u32 v35, v34, 4, v35
  v_add_u32 v8, s73, v35
  v_lshrrev_b32 v33, 4, v32
  v_bfe_u32 v34, v32, 1, 3
  v_and_b32 v35, 7, v33
  v_xor_b32 v34, v34, v35
  v_lshlrev_b32 v34, 5, v34
  v_and_b32 v35, 1, v32
  v_lshl_add_u32 v34, v35, 4, v34
  v_and_b32 v35, 0x33, v33
  v_bfe_u32 v36, v33, 2, 1
  v_lshl_or_b32 v35, v36, 3, v35
  v_bfe_u32 v36, v33, 3, 1
  v_lshl_or_b32 v35, v36, 2, v35
  v_lshl_add_u32 v35, v35, 11, v34
  v_add_u32 v12, s75, v35
  s_lshl_b32 s74, s56, 8
  s_add_u32 s74, s74, 64
  v_add_u32 v32, s74, v1
  v_lshrrev_b32 v33, 3, v32
  v_and_b32 v34, 7, v32
  v_and_b32 v35, 7, v33
  v_xor_b32 v34, v34, v35
  v_lshlrev_b32 v35, 7, v33
  v_lshl_add_u32 v35, v34, 4, v35
  v_add_u32 v9, s73, v35
  v_lshrrev_b32 v33, 4, v32
  v_bfe_u32 v34, v32, 1, 3
  v_and_b32 v35, 7, v33
  v_xor_b32 v34, v34, v35
  v_lshlrev_b32 v34, 5, v34
  v_and_b32 v35, 1, v32
  v_lshl_add_u32 v34, v35, 4, v34
  v_and_b32 v35, 0x33, v33
  v_bfe_u32 v36, v33, 2, 1
  v_lshl_or_b32 v35, v36, 3, v35
  v_bfe_u32 v36, v33, 3, 1
  v_lshl_or_b32 v35, v36, 2, v35
  v_lshl_add_u32 v35, v35, 11, v34
  v_add_u32 v13, s75, v35
  s_lshl_b32 s74, s56, 8
  s_add_u32 s74, s74, 128
  v_add_u32 v32, s74, v1
  v_lshrrev_b32 v33, 3, v32
  v_and_b32 v34, 7, v32
  v_and_b32 v35, 7, v33
  v_xor_b32 v34, v34, v35
  v_lshlrev_b32 v35, 7, v33
  v_lshl_add_u32 v35, v34, 4, v35
  v_add_u32 v10, s73, v35
  v_lshrrev_b32 v33, 4, v32
  v_bfe_u32 v34, v32, 1, 3
  v_and_b32 v35, 7, v33
  v_xor_b32 v34, v34, v35
  v_lshlrev_b32 v34, 5, v34
  v_and_b32 v35, 1, v32
  v_lshl_add_u32 v34, v35, 4, v34
  v_and_b32 v35, 0x33, v33
  v_bfe_u32 v36, v33, 2, 1
  v_lshl_or_b32 v35, v36, 3, v35
  v_bfe_u32 v36, v33, 3, 1
  v_lshl_or_b32 v35, v36, 2, v35
  v_lshl_add_u32 v35, v35, 11, v34
  v_add_u32 v14, s75, v35
  s_lshl_b32 s74, s56, 8
  s_add_u32 s74, s74, 192
  v_add_u32 v32, s74, v1
  v_lshrrev_b32 v33, 3, v32
  v_and_b32 v34, 7, v32
  v_and_b32 v35, 7, v33
  v_xor_b32 v34, v34, v35
  v_lshlrev_b32 v35, 7, v33
  v_lshl_add_u32 v35, v34, 4, v35
  v_add_u32 v11, s73, v35
  v_lshrrev_b32 v33, 4, v32
  v_bfe_u32 v34, v32, 1, 3
  v_and_b32 v35, 7, v33
  v_xor_b32 v34, v34, v35
  v_lshlrev_b32 v34, 5, v34
  v_and_b32 v35, 1, v32
  v_lshl_add_u32 v34, v35, 4, v34
  v_and_b32 v35, 0x33, v33
  v_bfe_u32 v36, v33, 2, 1
  v_lshl_or_b32 v35, v36, 3, v35
  v_bfe_u32 v36, v33, 3, 1
  v_lshl_or_b32 v35, v36, 2, v35
  v_lshl_add_u32 v35, v35, 11, v34
  v_add_u32 v15, s75, v35
  v_bfe_u32 v32, v1, 5, 1
  v_lshlrev_b32 v32, 4, v32
  v_bfe_u32 v33, v1, 4, 1
  v_lshlrev_b32 v33, 2, v33
  v_bfe_u32 v34, v1, 2, 2
  v_add_u32 v33, v33, v34
  v_add_u32 v32, v32, v33
  v_lshlrev_b32 v32, 8, v32
  v_and_b32 v34, 3, v1
  v_lshl_add_u32 v32, v34, 3, v32
  v_add_u32 v32, 16384, v32
  s_lshl_b32 s74, s88, 2
  s_add_u32 s75, s74, 0
  v_xor_b32 v34, s75, v33
  v_lshl_add_u32 v24, v34, 5, v32
  s_add_u32 s75, s74, 1
  v_xor_b32 v34, s75, v33
  v_lshl_add_u32 v25, v34, 5, v32
  s_add_u32 s75, s74, 2
  v_xor_b32 v34, s75, v33
  v_lshl_add_u32 v26, v34, 5, v32
  s_add_u32 s75, s74, 3
  v_xor_b32 v34, s75, v33
  v_lshl_add_u32 v27, v34, 5, v32
  s_and_b32 s77, s56, 1
  s_and_b32 s78, s58, 3
  s_lshl_b32 s78, s78, 5
  s_lshl_b32 s74, s77, 4
  s_add_u32 s78, s78, s74
  v_add_u32 v32, s78, v3
  v_mul_u32_u24 v33, 7168, v32
  v_add_u32 v33, s73, v33
  s_and_b32 s78, s57, 3
  s_lshl_b32 s78, s78, 4
  s_lshl_b32 s74, s77, 3
  s_add_u32 s78, s78, s74
  v_lshrrev_b32 v34, 1, v3
  v_add_u32 v34, s78, v34
  v_lshlrev_b32 v34, 11, v34
  v_and_b32 v35, 1, v3
  v_lshl_add_u32 v34, v35, 7, v34
  s_lshl_b32 s75, s58, 8
  v_add_u32 v34, s75, v34
  s_cmp_lt_u32 s56, 2
  s_cselect_b32 s96, s40, s44
  s_cselect_b32 s97, s41, s45
  s_cselect_b32 s98, s42, s46
  s_mov_b32 s99, 0x00020000
  s_mov_b32 s90, 131072
  s_cselect_b32 s90, 128, s90
  s_cselect_b64 vcc, -1, 0
  v_cndmask_b32 v28, v34, v33, vcc
  s_mul_i32 s89, s90, 4
  s_add_u32 s79, s62, s70
  s_add_u32 m0, s79, 0
  s_nop 0
  buffer_load_dwordx4 v8, s[40:43], s63 offen lds
  s_add_u32 m0, s79, 1024
  s_nop 0
  buffer_load_dwordx4 v9, s[40:43], s63 offen lds
  s_add_u32 m0, s79, 2048
  s_nop 0
  buffer_load_dwordx4 v10, s[40:43], s63 offen lds
  s_add_u32 m0, s79, 3072
  s_nop 0
  buffer_load_dwordx4 v11, s[40:43], s63 offen lds
  s_add_u32 m0, s79, 16384
  s_nop 0
  buffer_load_dwordx4 v12, s[44:47], s64 offen lds
  s_add_u32 m0, s79, 17408
  s_nop 0
  buffer_load_dwordx4 v13, s[44:47], s64 offen lds
  s_add_u32 m0, s79, 18432
  s_nop 0
  buffer_load_dwordx4 v14, s[44:47], s64 offen lds
  s_add_u32 m0, s79, 19456
  s_nop 0
  buffer_load_dwordx4 v15, s[44:47], s64 offen lds
  s_add_u32 s63, s63, 16384
  s_add_u32 s64, s64, 131072
  s_add_u32 s65, s65, 1
  s_add_u32 s62, s62, 32768
  s_cmp_ge_u32 s62, 131072
  s_cselect_b32 s62, 0, s62
  s_cmp_ge_u32 s65, 56
  s_cselect_b32 s42, 0, s42
  s_cselect_b32 s46, 0, s46
  s_add_u32 s79, s62, s70
  s_add_u32 m0, s79, 0
  s_nop 0
  buffer_load_dwordx4 v8, s[40:43], s63 offen lds
  s_add_u32 m0, s79, 1024
  s_nop 0
  buffer_load_dwordx4 v9, s[40:43], s63 offen lds
  s_add_u32 m0, s79, 2048
  s_nop 0
  buffer_load_dwordx4 v10, s[40:43], s63 offen lds
  s_add_u32 m0, s79, 3072
  s_nop 0
  buffer_load_dwordx4 v11, s[40:43], s63 offen lds
  s_add_u32 m0, s79, 16384
  s_nop 0
  buffer_load_dwordx4 v12, s[44:47], s64 offen lds
  s_add_u32 m0, s79, 17408
  s_nop 0
  buffer_load_dwordx4 v13, s[44:47], s64 offen lds
  s_add_u32 m0, s79, 18432
  s_nop 0
  buffer_load_dwordx4 v14, s[44:47], s64 offen lds
  s_add_u32 m0, s79, 19456
  s_nop 0
  buffer_load_dwordx4 v15, s[44:47], s64 offen lds
  s_add_u32 s63, s63, 16384
  s_add_u32 s64, s64, 131072
  s_add_u32 s65, s65, 1
  s_add_u32 s62, s62, 32768
  s_cmp_ge_u32 s62, 131072
  s_cselect_b32 s62, 0, s62
  s_cmp_ge_u32 s65, 56
  s_cselect_b32 s42, 0, s42
  s_cselect_b32 s46, 0, s46
  s_add_u32 s79, s62, s70
  s_add_u32 m0, s79, 0
  s_nop 0
  buffer_load_dwordx4 v8, s[40:43], s63 offen lds
  s_add_u32 m0, s79, 1024
  s_nop 0
  buffer_load_dwordx4 v9, s[40:43], s63 offen lds
  s_add_u32 m0, s79, 2048
  s_nop 0
  buffer_load_dwordx4 v10, s[40:43], s63 offen lds
  s_add_u32 m0, s79, 3072
  s_nop 0
  buffer_load_dwordx4 v11, s[40:43], s63 offen lds
  s_add_u32 m0, s79, 16384
  s_nop 0
  buffer_load_dwordx4 v12, s[44:47], s64 offen lds
  s_add_u32 m0, s79, 17408
  s_nop 0
  buffer_load_dwordx4 v13, s[44:47], s64 offen lds
  s_add_u32 m0, s79, 18432
  s_nop 0
  buffer_load_dwordx4 v14, s[44:47], s64 offen lds
  s_add_u32 m0, s79, 19456
  s_nop 0
  buffer_load_dwordx4 v15, s[44:47], s64 offen lds
  s_add_u32 s63, s63, 16384
  s_add_u32 s64, s64, 131072
  s_add_u32 s65, s65, 1
  s_add_u32 s62, s62, 32768
  s_cmp_ge_u32 s62, 131072
  s_cselect_b32 s62, 0, s62
  s_cmp_ge_u32 s65, 56
  s_cselect_b32 s42, 0, s42
  s_cselect_b32 s46, 0, s46
  s_add_u32 s79, s62, s70
  s_add_u32 m0, s79, 0
  s_nop 0
  buffer_load_dwordx4 v8, s[40:43], s63 offen lds
  s_add_u32 m0, s79, 1024
  s_nop 0
  buffer_load_dwordx4 v9, s[40:43], s63 offen lds
  s_add_u32 m0, s79, 2048
  s_nop 0
  buffer_load_dwordx4 v10, s[40:43], s63 offen lds
  s_add_u32 m0, s79, 3072
  s_nop 0
  buffer_load_dwordx4 v11, s[40:43], s63 offen lds
  s_add_u32 s48, s36, 0x2400000
  s_addc_u32 s49, s37, 0
  s_mov_b32 s50, 0x2000
  s_mov_b32 s51, 0x00020000
  s_lshl_b32 s74, s57, 7
  s_lshl_b32 s75, s87, 6
  s_add_u32 s74, s74, s75
  v_add_u32 v32, s74, v3
  v_lshlrev_b32 v33, 2, v32
  buffer_load_dword v40, v33, s[48:51], 0 offen offset:0
  buffer_load_dword v41, v33, s[48:51], 0 offen offset:64
  buffer_load_dword v42, v33, s[48:51], 0 offen offset:128
  buffer_load_dword v43, v33, s[48:51], 0 offen offset:192
  s_add_u32 s52, s36, 0x2000000
  s_addc_u32 s53, s37, 0
  s_mov_b32 s54, 0x400000
  s_mov_b32 s55, 0x00020000
  s_lshl_b32 s74, s58, 8
  s_lshl_b32 s75, s88, 7
  s_add_u32 s74, s74, s75
  v_lshlrev_b32 v34, 11, v32
  v_lshl_add_u32 v34, v4, 3, v34
  v_add_u32 v34, s74, v34
  s_waitcnt vmcnt(24)
  s_barrier
  ds_read_b128 v[128:131], v20 offset:0
  ds_read_b128 v[132:135], v20 offset:2048
  ds_read_b128 v[136:139], v20 offset:4096
  ds_read_b128 v[140:143], v20 offset:6144
  ds_read_b64_tr_b16 v[144:145], v24 offset:0
  ds_read_b64_tr_b16 v[146:147], v24 offset:2048
  ds_read_b64_tr_b16 v[148:149], v25 offset:0
  ds_read_b64_tr_b16 v[150:151], v25 offset:2048
  ds_read_b64_tr_b16 v[152:153], v26 offset:0
  ds_read_b64_tr_b16 v[154:155], v26 offset:2048
  ds_read_b64_tr_b16 v[156:157], v27 offset:0
  ds_read_b64_tr_b16 v[158:159], v27 offset:2048
  s_mov_b32 s84, 0
K2_A_7:
  s_waitcnt lgkmcnt(0)
  v_mfma_f32_16x16x32_bf16 v[64:67], v[144:147], v[128:131], v[64:67]
  ds_read_b128 v[160:163], v21 offset:0
  ds_read_b128 v[164:167], v21 offset:2048
  v_mfma_f32_16x16x32_bf16 v[68:71], v[144:147], v[132:135], v[68:71]
  s_add_u32 m0, s79, 16384
  s_nop 0
  buffer_load_dwordx4 v12, s[44:47], s64 offen lds
  v_mfma_f32_16x16x32_bf16 v[72:75], v[144:147], v[136:139], v[72:75]
  ds_read_b128 v[168:171], v21 offset:4096
  v_mfma_f32_16x16x32_bf16 v[76:79], v[144:147], v[140:143], v[76:79]
  ds_read_b128 v[172:175], v21 offset:6144
  s_add_u32 m0, s79, 17408
  v_mfma_f32_16x16x32_bf16 v[80:83], v[148:151], v[128:131], v[80:83]
  buffer_load_dwordx4 v13, s[44:47], s64 offen lds
  v_mfma_f32_16x16x32_bf16 v[84:87], v[148:151], v[132:135], v[84:87]
  ds_read_b64_tr_b16 v[176:177], v24 offset:8192
  ds_read_b64_tr_b16 v[178:179], v24 offset:10240
  v_mfma_f32_16x16x32_bf16 v[88:91], v[148:151], v[136:139], v[88:91]
  s_add_u32 m0, s79, 18432
  v_mfma_f32_16x16x32_bf16 v[92:95], v[148:151], v[140:143], v[92:95]
  buffer_load_dwordx4 v14, s[44:47], s64 offen lds
  ds_read_b64_tr_b16 v[180:181], v25 offset:8192
  v_mfma_f32_16x16x32_bf16 v[96:99], v[152:155], v[128:131], v[96:99]
  s_add_u32 m0, s79, 19456
  v_mfma_f32_16x16x32_bf16 v[100:103], v[152:155], v[132:135], v[100:103]
  buffer_load_dwordx4 v15, s[44:47], s64 offen lds
  ds_read_b64_tr_b16 v[182:183], v25 offset:10240
  v_mfma_f32_16x16x32_bf16 v[104:107], v[152:155], v[136:139], v[104:107]
  ds_read_b64_tr_b16 v[184:185], v26 offset:8192
  v_mfma_f32_16x16x32_bf16 v[108:111], v[152:155], v[140:143], v[108:111]
  s_add_u32 s63, s63, 16384
  s_add_u32 s64, s64, 131072
  s_add_u32 s65, s65, 1
  ds_read_b64_tr_b16 v[186:187], v26 offset:10240
  v_mfma_f32_16x16x32_bf16 v[112:115], v[156:159], v[128:131], v[112:115]
  ds_read_b64_tr_b16 v[188:189], v27 offset:8192
  v_mfma_f32_16x16x32_bf16 v[116:119], v[156:159], v[132:135], v[116:119]
  s_add_u32 s62, s62, 32768
  s_cmp_ge_u32 s62, 131072
  s_cselect_b32 s62, 0, s62
  ds_read_b64_tr_b16 v[190:191], v27 offset:10240
  v_mfma_f32_16x16x32_bf16 v[120:123], v[156:159], v[136:139], v[120:123]
  s_cmp_ge_u32 s65, 56
  s_cselect_b32 s42, 0, s42
  s_cselect_b32 s46, 0, s46
  v_mfma_f32_16x16x32_bf16 v[124:127], v[156:159], v[140:143], v[124:127]
  s_waitcnt vmcnt(16) lgkmcnt(0)
  s_barrier
  v_mfma_f32_16x16x32_bf16 v[64:67], v[176:179], v[160:163], v[64:67]
  s_add_u32 s71, s71, 1
  s_cmp_ge_u32 s71, 4
  s_mov_b32 s72, 32768
  s_cselect_b32 s72, 4294868992, s72
  s_cselect_b32 s71, 0, s71
  v_add_u32 v20, s72, v20
  v_mfma_f32_16x16x32_bf16 v[68:71], v[176:179], v[164:167], v[68:71]
  v_add_u32 v21, s72, v21
  v_add_u32 v24, s72, v24
  v_mfma_f32_16x16x32_bf16 v[72:75], v[176:179], v[168:171], v[72:75]
  v_add_u32 v25, s72, v25
  v_add_u32 v26, s72, v26
  v_mfma_f32_16x16x32_bf16 v[76:79], v[176:179], v[172:175], v[76:79]
  v_add_u32 v27, s72, v27
  ds_read_b128 v[128:131], v20 offset:0
  v_mfma_f32_16x16x32_bf16 v[80:83], v[180:183], v[160:163], v[80:83]
  ds_read_b128 v[132:135], v20 offset:2048
  v_mfma_f32_16x16x32_bf16 v[84:87], v[180:183], v[164:167], v[84:87]
  ds_read_b128 v[136:139], v20 offset:4096
  s_add_u32 s79, s62, s70
  s_add_u32 m0, s79, 0
  v_mfma_f32_16x16x32_bf16 v[88:91], v[180:183], v[168:171], v[88:91]
  buffer_load_dwordx4 v8, s[40:43], s63 offen lds
  ds_read_b128 v[140:143], v20 offset:6144
  v_mfma_f32_16x16x32_bf16 v[92:95], v[180:183], v[172:175], v[92:95]
  ds_read_b64_tr_b16 v[144:145], v24 offset:0
  ds_read_b64_tr_b16 v[146:147], v24 offset:2048
  v_mfma_f32_16x16x32_bf16 v[96:99], v[184:187], v[160:163], v[96:99]
  s_add_u32 m0, s79, 1024
  s_nop 0
  buffer_load_dwordx4 v9, s[40:43], s63 offen lds
  v_mfma_f32_16x16x32_bf16 v[100:103], v[184:187], v[164:167], v[100:103]
  ds_read_b64_tr_b16 v[148:149], v25 offset:0
  v_mfma_f32_16x16x32_bf16 v[104:107], v[184:187], v[168:171], v[104:107]
  ds_read_b64_tr_b16 v[150:151], v25 offset:2048
  ds_read_b64_tr_b16 v[152:153], v26 offset:0
  v_mfma_f32_16x16x32_bf16 v[108:111], v[184:187], v[172:175], v[108:111]
  s_add_u32 m0, s79, 2048
  s_nop 0
  buffer_load_dwordx4 v10, s[40:43], s63 offen lds
  v_mfma_f32_16x16x32_bf16 v[112:115], v[188:191], v[160:163], v[112:115]
  ds_read_b64_tr_b16 v[154:155], v26 offset:2048
  ds_read_b64_tr_b16 v[156:157], v27 offset:0
  v_mfma_f32_16x16x32_bf16 v[116:119], v[188:191], v[164:167], v[116:119]
  ds_read_b64_tr_b16 v[158:159], v27 offset:2048
  s_add_u32 m0, s79, 3072
  v_mfma_f32_16x16x32_bf16 v[120:123], v[188:191], v[168:171], v[120:123]
  buffer_load_dwordx4 v11, s[40:43], s63 offen lds
  v_mfma_f32_16x16x32_bf16 v[124:127], v[188:191], v[172:175], v[124:127]
  s_add_u32 s84, s84, 1
  s_cmp_lt_u32 s84, 56
  s_cbranch_scc1 K2_A_7
  v_sub_f32 v40, 1.0, v40
  v_cvt_pk_bf16_f32 v44, v40, v40
  v_lshlrev_b32 v40, 16, v44
  v_sub_f32 v41, 1.0, v41
  v_cvt_pk_bf16_f32 v44, v41, v41
  v_lshlrev_b32 v41, 16, v44
  v_sub_f32 v42, 1.0, v42
  v_cvt_pk_bf16_f32 v44, v42, v42
  v_lshlrev_b32 v42, 16, v44
  v_sub_f32 v43, 1.0, v43
  v_cvt_pk_bf16_f32 v44, v43, v43
  v_lshlrev_b32 v43, 16, v44
  v_cvt_pk_bf16_f32 v44, v64, v65
  v_cvt_pk_bf16_f32 v45, v66, v67
  v_lshlrev_b32 v46, 16, v44
  v_and_b32 v47, 0xffff0000, v44
  v_lshlrev_b32 v48, 16, v45
  v_and_b32 v49, 0xffff0000, v45
  v_mul_f32 v46, v46, v40
  v_mul_f32 v47, v47, v40
  v_mul_f32 v48, v48, v40
  v_mul_f32 v49, v49, v40
  v_cvt_pk_bf16_f32 v50, v46, v47
  v_cvt_pk_bf16_f32 v51, v48, v49
  buffer_store_dwordx2 v[50:51], v34, s[52:55], 0 offen offset:0 sc0 sc1
  v_cvt_pk_bf16_f32 v44, v80, v81
  v_cvt_pk_bf16_f32 v45, v82, v83
  v_lshlrev_b32 v46, 16, v44
  v_and_b32 v47, 0xffff0000, v44
  v_lshlrev_b32 v48, 16, v45
  v_and_b32 v49, 0xffff0000, v45
  v_mul_f32 v46, v46, v40
  v_mul_f32 v47, v47, v40
  v_mul_f32 v48, v48, v40
  v_mul_f32 v49, v49, v40
  v_cvt_pk_bf16_f32 v52, v46, v47
  v_cvt_pk_bf16_f32 v53, v48, v49
  buffer_store_dwordx2 v[52:53], v34, s[52:55], 0 offen offset:32 sc0 sc1
  v_cvt_pk_bf16_f32 v44, v96, v97
  v_cvt_pk_bf16_f32 v45, v98, v99
  v_lshlrev_b32 v46, 16, v44
  v_and_b32 v47, 0xffff0000, v44
  v_lshlrev_b32 v48, 16, v45
  v_and_b32 v49, 0xffff0000, v45
  v_mul_f32 v46, v46, v40
  v_mul_f32 v47, v47, v40
  v_mul_f32 v48, v48, v40
  v_mul_f32 v49, v49, v40
  v_cvt_pk_bf16_f32 v54, v46, v47
  v_cvt_pk_bf16_f32 v55, v48, v49
  buffer_store_dwordx2 v[54:55], v34, s[52:55], 0 offen offset:64 sc0 sc1
  v_cvt_pk_bf16_f32 v44, v112, v113
  v_cvt_pk_bf16_f32 v45, v114, v115
  v_lshlrev_b32 v46, 16, v44
  v_and_b32 v47, 0xffff0000, v44
  v_lshlrev_b32 v48, 16, v45
  v_and_b32 v49, 0xffff0000, v45
  v_mul_f32 v46, v46, v40
  v_mul_f32 v47, v47, v40
  v_mul_f32 v48, v48, v40
  v_mul_f32 v49, v49, v40
  v_cvt_pk_bf16_f32 v56, v46, v47
  v_cvt_pk_bf16_f32 v57, v48, v49
  buffer_store_dwordx2 v[56:57], v34, s[52:55], 0 offen offset:96 sc0 sc1
  v_add_u32 v34, 32768, v34
  v_cvt_pk_bf16_f32 v44, v68, v69
  v_cvt_pk_bf16_f32 v45, v70, v71
  v_lshlrev_b32 v46, 16, v44
  v_and_b32 v47, 0xffff0000, v44
  v_lshlrev_b32 v48, 16, v45
  v_and_b32 v49, 0xffff0000, v45
  v_mul_f32 v46, v46, v41
  v_mul_f32 v47, v47, v41
  v_mul_f32 v48, v48, v41
  v_mul_f32 v49, v49, v41
  v_cvt_pk_bf16_f32 v50, v46, v47
  v_cvt_pk_bf16_f32 v51, v48, v49
  buffer_store_dwordx2 v[50:51], v34, s[52:55], 0 offen offset:0 sc0 sc1
  v_cvt_pk_bf16_f32 v44, v84, v85
  v_cvt_pk_bf16_f32 v45, v86, v87
  v_lshlrev_b32 v46, 16, v44
  v_and_b32 v47, 0xffff0000, v44
  v_lshlrev_b32 v48, 16, v45
  v_and_b32 v49, 0xffff0000, v45
  v_mul_f32 v46, v46, v41
  v_mul_f32 v47, v47, v41
  v_mul_f32 v48, v48, v41
  v_mul_f32 v49, v49, v41
  v_cvt_pk_bf16_f32 v52, v46, v47
  v_cvt_pk_bf16_f32 v53, v48, v49
  buffer_store_dwordx2 v[52:53], v34, s[52:55], 0 offen offset:32 sc0 sc1
  v_cvt_pk_bf16_f32 v44, v100, v101
  v_cvt_pk_bf16_f32 v45, v102, v103
  v_lshlrev_b32 v46, 16, v44
  v_and_b32 v47, 0xffff0000, v44
  v_lshlrev_b32 v48, 16, v45
  v_and_b32 v49, 0xffff0000, v45
  v_mul_f32 v46, v46, v41
  v_mul_f32 v47, v47, v41
  v_mul_f32 v48, v48, v41
  v_mul_f32 v49, v49, v41
  v_cvt_pk_bf16_f32 v54, v46, v47
  v_cvt_pk_bf16_f32 v55, v48, v49
  buffer_store_dwordx2 v[54:55], v34, s[52:55], 0 offen offset:64 sc0 sc1
  v_cvt_pk_bf16_f32 v44, v116, v117
  v_cvt_pk_bf16_f32 v45, v118, v119
  v_lshlrev_b32 v46, 16, v44
  v_and_b32 v47, 0xffff0000, v44
  v_lshlrev_b32 v48, 16, v45
  v_and_b32 v49, 0xffff0000, v45
  v_mul_f32 v46, v46, v41
  v_mul_f32 v47, v47, v41
  v_mul_f32 v48, v48, v41
  v_mul_f32 v49, v49, v41
  v_cvt_pk_bf16_f32 v56, v46, v47
  v_cvt_pk_bf16_f32 v57, v48, v49
  buffer_store_dwordx2 v[56:57], v34, s[52:55], 0 offen offset:96 sc0 sc1
  v_add_u32 v34, 32768, v34
  v_cvt_pk_bf16_f32 v44, v72, v73
  v_cvt_pk_bf16_f32 v45, v74, v75
  v_lshlrev_b32 v46, 16, v44
  v_and_b32 v47, 0xffff0000, v44
  v_lshlrev_b32 v48, 16, v45
  v_and_b32 v49, 0xffff0000, v45
  v_mul_f32 v46, v46, v42
  v_mul_f32 v47, v47, v42
  v_mul_f32 v48, v48, v42
  v_mul_f32 v49, v49, v42
  v_cvt_pk_bf16_f32 v50, v46, v47
  v_cvt_pk_bf16_f32 v51, v48, v49
  buffer_store_dwordx2 v[50:51], v34, s[52:55], 0 offen offset:0 sc0 sc1
  v_cvt_pk_bf16_f32 v44, v88, v89
  v_cvt_pk_bf16_f32 v45, v90, v91
  v_lshlrev_b32 v46, 16, v44
  v_and_b32 v47, 0xffff0000, v44
  v_lshlrev_b32 v48, 16, v45
  v_and_b32 v49, 0xffff0000, v45
  v_mul_f32 v46, v46, v42
  v_mul_f32 v47, v47, v42
  v_mul_f32 v48, v48, v42
  v_mul_f32 v49, v49, v42
  v_cvt_pk_bf16_f32 v52, v46, v47
  v_cvt_pk_bf16_f32 v53, v48, v49
  buffer_store_dwordx2 v[52:53], v34, s[52:55], 0 offen offset:32 sc0 sc1
  v_cvt_pk_bf16_f32 v44, v104, v105
  v_cvt_pk_bf16_f32 v45, v106, v107
  v_lshlrev_b32 v46, 16, v44
  v_and_b32 v47, 0xffff0000, v44
  v_lshlrev_b32 v48, 16, v45
  v_and_b32 v49, 0xffff0000, v45
  v_mul_f32 v46, v46, v42
  v_mul_f32 v47, v47, v42
  v_mul_f32 v48, v48, v42
  v_mul_f32 v49, v49, v42
  v_cvt_pk_bf16_f32 v54, v46, v47
  v_cvt_pk_bf16_f32 v55, v48, v49
  buffer_store_dwordx2 v[54:55], v34, s[52:55], 0 offen offset:64 sc0 sc1
  v_cvt_pk_bf16_f32 v44, v120, v121
  v_cvt_pk_bf16_f32 v45, v122, v123
  v_lshlrev_b32 v46, 16, v44
  v_and_b32 v47, 0xffff0000, v44
  v_lshlrev_b32 v48, 16, v45
  v_and_b32 v49, 0xffff0000, v45
  v_mul_f32 v46, v46, v42
  v_mul_f32 v47, v47, v42
  v_mul_f32 v48, v48, v42
  v_mul_f32 v49, v49, v42
  v_cvt_pk_bf16_f32 v56, v46, v47
  v_cvt_pk_bf16_f32 v57, v48, v49
  buffer_store_dwordx2 v[56:57], v34, s[52:55], 0 offen offset:96 sc0 sc1
  v_add_u32 v34, 32768, v34
  v_cvt_pk_bf16_f32 v44, v76, v77
  v_cvt_pk_bf16_f32 v45, v78, v79
  v_lshlrev_b32 v46, 16, v44
  v_and_b32 v47, 0xffff0000, v44
  v_lshlrev_b32 v48, 16, v45
  v_and_b32 v49, 0xffff0000, v45
  v_mul_f32 v46, v46, v43
  v_mul_f32 v47, v47, v43
  v_mul_f32 v48, v48, v43
  v_mul_f32 v49, v49, v43
  v_cvt_pk_bf16_f32 v50, v46, v47
  v_cvt_pk_bf16_f32 v51, v48, v49
  buffer_store_dwordx2 v[50:51], v34, s[52:55], 0 offen offset:0 sc0 sc1
  v_cvt_pk_bf16_f32 v44, v92, v93
  v_cvt_pk_bf16_f32 v45, v94, v95
  v_lshlrev_b32 v46, 16, v44
  v_and_b32 v47, 0xffff0000, v44
  v_lshlrev_b32 v48, 16, v45
  v_and_b32 v49, 0xffff0000, v45
  v_mul_f32 v46, v46, v43
  v_mul_f32 v47, v47, v43
  v_mul_f32 v48, v48, v43
  v_mul_f32 v49, v49, v43
  v_cvt_pk_bf16_f32 v52, v46, v47
  v_cvt_pk_bf16_f32 v53, v48, v49
  buffer_store_dwordx2 v[52:53], v34, s[52:55], 0 offen offset:32 sc0 sc1
  v_cvt_pk_bf16_f32 v44, v108, v109
  v_cvt_pk_bf16_f32 v45, v110, v111
  v_lshlrev_b32 v46, 16, v44
  v_and_b32 v47, 0xffff0000, v44
  v_lshlrev_b32 v48, 16, v45
  v_and_b32 v49, 0xffff0000, v45
  v_mul_f32 v46, v46, v43
  v_mul_f32 v47, v47, v43
  v_mul_f32 v48, v48, v43
  v_mul_f32 v49, v49, v43
  v_cvt_pk_bf16_f32 v54, v46, v47
  v_cvt_pk_bf16_f32 v55, v48, v49
  buffer_store_dwordx2 v[54:55], v34, s[52:55], 0 offen offset:64 sc0 sc1
  v_cvt_pk_bf16_f32 v44, v124, v125
  v_cvt_pk_bf16_f32 v45, v126, v127
  v_lshlrev_b32 v46, 16, v44
  v_and_b32 v47, 0xffff0000, v44
  v_lshlrev_b32 v48, 16, v45
  v_and_b32 v49, 0xffff0000, v45
  v_mul_f32 v46, v46, v43
  v_mul_f32 v47, v47, v43
  v_mul_f32 v48, v48, v43
  v_mul_f32 v49, v49, v43
  v_cvt_pk_bf16_f32 v56, v46, v47
  v_cvt_pk_bf16_f32 v57, v48, v49
  buffer_store_dwordx2 v[56:57], v34, s[52:55], 0 offen offset:96 sc0 sc1
  s_mov_b32 s48, s34
  s_mov_b32 s49, s35
  s_mov_b32 s50, 0x100
  s_mov_b32 s51, 0x00020000
  s_lshr_b32 s74, s60, 1
  s_lshl_b32 s74, s74, 2
  s_and_b32 s75, s60, 1
  s_lshl_b32 s75, 1, s75
  s_waitcnt vmcnt(0)
  s_barrier
  s_cmp_lg_u32 s56, 0
  s_cbranch_scc1 K2_A_done
  s_mov_b64 exec, 1
  v_mov_b32 v20, s75
  v_mov_b32 v21, 0
  buffer_atomic_or v20, v21, s[48:51], s74 offen sc1
  s_mov_b64 exec, -1
K2_A_done:
  s_branch K2_end
K2_typeB:
  s_add_u32 s40, s36, 0x1000000
  s_addc_u32 s41, s37, 0
  s_mov_b32 s42, 0x800000
  s_mov_b32 s43, 0x00020000
  s_add_u32 s48, s36, 0x1800000
  s_addc_u32 s49, s37, 0
  s_mov_b32 s50, 0x800000
  s_mov_b32 s51, 0x00020000
  s_mov_b32 s44, s14
  s_mov_b32 s45, s15
  s_mov_b32 s46, 0x200000
  s_mov_b32 s47, 0x00020000
  s_lshl_b32 s73, s57, 19
  s_lshl_b32 s75, s58, 18
  s_lshl_b32 s74, s56, 8
  s_add_u32 s74, s74, 0
  v_add_u32 v32, s74, v1
  v_lshrrev_b32 v33, 3, v32
  v_and_b32 v34, 7, v32
  v_and_b32 v35, 7, v33
  v_xor_b32 v34, v34, v35
  v_lshlrev_b32 v34, 4, v34
  v_lshl_add_u32 v35, v33, 7, v34
  v_add_u32 v8, s73, v35
  v_lshl_add_u32 v35, v33, 11, v34
  v_add_u32 v12, s75, v35
  s_lshl_b32 s74, s56, 8
  s_add_u32 s74, s74, 64
  v_add_u32 v32, s74, v1
  v_lshrrev_b32 v33, 3, v32
  v_and_b32 v34, 7, v32
  v_and_b32 v35, 7, v33
  v_xor_b32 v34, v34, v35
  v_lshlrev_b32 v34, 4, v34
  v_lshl_add_u32 v35, v33, 7, v34
  v_add_u32 v9, s73, v35
  v_lshl_add_u32 v35, v33, 11, v34
  v_add_u32 v13, s75, v35
  s_lshl_b32 s74, s56, 8
  s_add_u32 s74, s74, 128
  v_add_u32 v32, s74, v1
  v_lshrrev_b32 v33, 3, v32
  v_and_b32 v34, 7, v32
  v_and_b32 v35, 7, v33
  v_xor_b32 v34, v34, v35
  v_lshlrev_b32 v34, 4, v34
  v_lshl_add_u32 v35, v33, 7, v34
  v_add_u32 v10, s73, v35
  v_lshl_add_u32 v35, v33, 11, v34
  v_add_u32 v14, s75, v35
  s_lshl_b32 s74, s56, 8
  s_add_u32 s74, s74, 192
  v_add_u32 v32, s74, v1
  v_lshrrev_b32 v33, 3, v32
  v_and_b32 v34, 7, v32
  v_and_b32 v35, 7, v33
  v_xor_b32 v34, v34, v35
  v_lshlrev_b32 v34, 4, v34
  v_lshl_add_u32 v35, v33, 7, v34
  v_add_u32 v11, s73, v35
  v_lshl_add_u32 v35, v33, 11, v34
  v_add_u32 v15, s75, v35
  s_lshl_b32 s74, s88, 13
  s_add_u32 s74, s74, 32768
  v_add_u32 v24, s74, v31
  v_xor_b32 v25, 64, v24
  s_and_b32 s77, s56, 1
  s_lshl_b32 s77, s77, 6
  v_add_u32 v32, s77, v1
  v_lshlrev_b32 v33, 12, v32
  v_add_u32 v28, s73, v33
  v_lshlrev_b32 v33, 11, v32
  v_add_u32 v29, s75, v33
  s_cmp_lt_u32 s56, 2
  s_cselect_b32 s96, s40, s48
  s_cselect_b32 s97, s41, s49
  s_mov_b32 s98, s42
  s_mov_b32 s99, 0x00020000
  s_mov_b32 s92, s14
  s_mov_b32 s93, s15
  s_mov_b32 s94, 0x200000
  s_mov_b32 s95, 0x00020000
  s_mov_b32 s89, 384
  s_mov_b32 s90, 384
  s_mov_b32 s91, 3
  s_add_u32 s79, s62, s70
  s_add_u32 m0, s79, 0
  s_nop 0
  buffer_load_dwordx4 v8, s[40:43], s63 offen lds
  s_add_u32 m0, s79, 1024
  s_nop 0
  buffer_load_dwordx4 v9, s[40:43], s63 offen lds
  s_add_u32 m0, s79, 2048
  s_nop 0
  buffer_load_dwordx4 v10, s[40:43], s63 offen lds
  s_add_u32 m0, s79, 3072
  s_nop 0
  buffer_load_dwordx4 v11, s[40:43], s63 offen lds
  s_add_u32 m0, s79, 16384
  s_nop 0
  buffer_load_dwordx4 v8, s[48:51], s63 offen lds
  s_add_u32 m0, s79, 17408
  s_nop 0
  buffer_load_dwordx4 v9, s[48:51], s63 offen lds
  s_add_u32 m0, s79, 18432
  s_nop 0
  buffer_load_dwordx4 v10, s[48:51], s63 offen lds
  s_add_u32 m0, s79, 19456
  s_nop 0
  buffer_load_dwordx4 v11, s[48:51], s63 offen lds
  s_add_u32 m0, s79, 32768
  s_nop 0
  buffer_load_dwordx4 v12, s[44:47], s64 offen lds
  s_add_u32 m0, s79, 33792
  s_nop 0
  buffer_load_dwordx4 v13, s[44:47], s64 offen lds
  s_add_u32 m0, s79, 34816
  s_nop 0
  buffer_load_dwordx4 v14, s[44:47], s64 offen lds
  s_add_u32 m0, s79, 35840
  s_nop 0
  buffer_load_dwordx4 v15, s[44:47], s64 offen lds
  s_add_u32 s63, s63, 16384
  s_add_u32 s64, s64, 128
  s_add_u32 s65, s65, 1
  s_add_u32 s62, s62, 49152
  s_cmp_ge_u32 s62, 147456
  s_cselect_b32 s62, 0, s62
  s_cmp_eq_u32 s65, 16
  s_cselect_b32 s44, s16, s44
  s_cselect_b32 s45, s17, s45
  s_cselect_b32 s64, 0, s64
  s_cmp_ge_u32 s65, 32
  s_cselect_b32 s42, 0, s42
  s_cselect_b32 s46, 0, s46
  s_cselect_b32 s50, 0, s50
  s_add_u32 s79, s62, s70
  s_add_u32 m0, s79, 0
  s_nop 0
  buffer_load_dwordx4 v8, s[40:43], s63 offen lds
  s_add_u32 m0, s79, 1024
  s_nop 0
  buffer_load_dwordx4 v9, s[40:43], s63 offen lds
  s_add_u32 m0, s79, 2048
  s_nop 0
  buffer_load_dwordx4 v10, s[40:43], s63 offen lds
  s_add_u32 m0, s79, 3072
  s_nop 0
  buffer_load_dwordx4 v11, s[40:43], s63 offen lds
  s_add_u32 m0, s79, 16384
  s_nop 0
  buffer_load_dwordx4 v8, s[48:51], s63 offen lds
  s_add_u32 m0, s79, 17408
  s_nop 0
  buffer_load_dwordx4 v9, s[48:51], s63 offen lds
  s_add_u32 m0, s79, 18432
  s_nop 0
  buffer_load_dwordx4 v10, s[48:51], s63 offen lds
  s_add_u32 m0, s79, 19456
  s_nop 0
  buffer_load_dwordx4 v11, s[48:51], s63 offen lds
  s_add_u32 m0, s79, 32768
  s_nop 0
  buffer_load_dwordx4 v12, s[44:47], s64 offen lds
  s_add_u32 m0, s79, 33792
  s_nop 0
  buffer_load_dwordx4 v13, s[44:47], s64 offen lds
  s_add_u32 m0, s79, 34816
  s_nop 0
  buffer_load_dwordx4 v14, s[44:47], s64 offen lds
  s_add_u32 m0, s79, 35840
  s_nop 0
  buffer_load_dwordx4 v15, s[44:47], s64 offen lds
  s_add_u32 s63, s63, 16384
  s_add_u32 s64, s64, 128
  s_add_u32 s65, s65, 1
  s_add_u32 s62, s62, 49152
  s_cmp_ge_u32 s62, 147456
  s_cselect_b32 s62, 0, s62
  s_cmp_eq_u32 s65, 16
  s_cselect_b32 s44, s16, s44
  s_cselect_b32 s45, s17, s45
  s_cselect_b32 s64, 0, s64
  s_cmp_ge_u32 s65, 32
  s_cselect_b32 s42, 0, s42
  s_cselect_b32 s46, 0, s46
  s_cselect_b32 s50, 0, s50
  s_add_u32 s79, s62, s70
  s_add_u32 m0, s79, 0
  s_nop 0
  buffer_load_dwordx4 v8, s[40:43], s63 offen lds
  s_add_u32 m0, s79, 1024
  s_nop 0
  buffer_load_dwordx4 v9, s[40:43], s63 offen lds
  s_add_u32 m0, s79, 2048
  s_nop 0
  buffer_load_dwordx4 v10, s[40:43], s63 offen lds
  s_add_u32 m0, s79, 3072
  s_nop 0
  buffer_load_dwordx4 v11, s[40:43], s63 offen lds
  s_add_u32 m0, s79, 16384
  s_nop 0
  buffer_load_dwordx4 v8, s[48:51], s63 offen lds
  s_add_u32 m0, s79, 17408
  s_nop 0
  buffer_load_dwordx4 v9, s[48:51], s63 offen lds
  s_add_u32 s52, s36, 0x2400000
  s_addc_u32 s53, s37, 0
  s_mov_b32 s54, 0x2000
  s_mov_b32 s55, 0x00020000
  s_lshl_b32 s74, s57, 7
  s_lshl_b32 s77, s87, 6
  s_add_u32 s74, s74, s77
  v_add_u32 v32, s74, v3
  v_lshlrev_b32 v33, 2, v32
  buffer_load_dword v40, v33, s[52:55], 0 offen offset:0
  buffer_load_dword v41, v33, s[52:55], 0 offen offset:64
  buffer_load_dword v42, v33, s[52:55], 0 offen offset:128
  buffer_load_dword v43, v33, s[52:55], 0 offen offset:192
  s_mov_b32 s52, s20
  s_mov_b32 s53, s21
  s_mov_b32 s54, 0x800
  s_mov_b32 s55, 0x00020000
  s_lshl_b32 s74, s58, 8
  s_lshl_b32 s77, s88, 7
  s_add_u32 s74, s74, s77
  v_lshl_add_u32 v35, v4, 3, s74
  buffer_load_dwordx2 v[44:45], v35, s[52:55], 0 offen offset:0
  buffer_load_dwordx2 v[46:47], v35, s[52:55], 0 offen offset:32
  buffer_load_dwordx2 v[48:49], v35, s[52:55], 0 offen offset:64
  buffer_load_dwordx2 v[50:51], v35, s[52:55], 0 offen offset:96
  v_lshl_add_u32 v36, v32, 11, v35
  s_mov_b32 s52, s4
  s_mov_b32 s53, s5
  s_mov_b32 s54, 0x400000
  s_mov_b32 s55, 0x00020000
  s_mov_b32 s74, 0
  buffer_load_dwordx2 v[224:225], v36, s[52:55], s74 offen offset:0
  s_mov_b32 s74, 0
  buffer_load_dwordx2 v[226:227], v36, s[52:55], s74 offen offset:32
  s_mov_b32 s74, 0
  buffer_load_dwordx2 v[228:229], v36, s[52:55], s74 offen offset:64
  s_mov_b32 s74, 0
  buffer_load_dwordx2 v[230:231], v36, s[52:55], s74 offen offset:96
  s_mov_b32 s74, 32768
  buffer_load_dwordx2 v[232:233], v36, s[52:55], s74 offen offset:0
  s_mov_b32 s74, 32768
  buffer_load_dwordx2 v[234:235], v36, s[52:55], s74 offen offset:32
  s_mov_b32 s74, 32768
  buffer_load_dwordx2 v[236:237], v36, s[52:55], s74 offen offset:64
  s_mov_b32 s74, 32768
  buffer_load_dwordx2 v[238:239], v36, s[52:55], s74 offen offset:96
  s_mov_b32 s74, 65536
  buffer_load_dwordx2 v[240:241], v36, s[52:55], s74 offen offset:0
  s_mov_b32 s74, 65536
  buffer_load_dwordx2 v[242:243], v36, s[52:55], s74 offen offset:32
  s_mov_b32 s74, 65536
  buffer_load_dwordx2 v[244:245], v36, s[52:55], s74 offen offset:64
  s_mov_b32 s74, 65536
  buffer_load_dwordx2 v[246:247], v36, s[52:55], s74 offen offset:96
  s_mov_b32 s74, 98304
  buffer_load_dwordx2 v[248:249], v36, s[52:55], s74 offen offset:0
  s_mov_b32 s74, 98304
  buffer_load_dwordx2 v[250:251], v36, s[52:55], s74 offen offset:32
  s_mov_b32 s74, 98304
  buffer_load_dwordx2 v[252:253], v36, s[52:55], s74 offen offset:64
  s_mov_b32 s74, 98304
  buffer_load_dwordx2 v[254:255], v36, s[52:55], s74 offen offset:96
  s_waitcnt vmcnt(42)
  s_barrier
  ds_read_b128 v[160:163], v24 offset:0
  ds_read_b128 v[164:167], v24 offset:2048
  ds_read_b128 v[168:171], v24 offset:4096
  ds_read_b128 v[172:175], v24 offset:6144
  ds_read_b128 v[128:131], v20 offset:0
  ds_read_b128 v[132:135], v20 offset:2048
  ds_read_b128 v[136:139], v20 offset:4096
  ds_read_b128 v[140:143], v20 offset:6144
  ds_read_b128 v[144:147], v20 offset:16384
  ds_read_b128 v[148:151], v20 offset:18432
  ds_read_b128 v[152:155], v20 offset:20480
  ds_read_b128 v[156:159], v20 offset:22528
  s_mov_b32 s84, 0
K2_B_8:
  s_waitcnt lgkmcnt(0)
  v_mfma_f32_16x16x32_bf16 v[64:67], v[160:163], v[128:131], v[64:67]
  ds_read_b128 v[208:211], v25 offset:0
  v_mfma_f32_16x16x32_bf16 v[68:71], v[160:163], v[132:135], v[68:71]
  ds_read_b128 v[212:215], v25 offset:2048
  v_mfma_f32_16x16x32_bf16 v[72:75], v[160:163], v[136:139], v[72:75]
  s_add_u32 m0, s79, 18432
  v_mfma_f32_16x16x32_bf16 v[76:79], v[160:163], v[140:143], v[76:79]
  buffer_load_dwordx4 v10, s[48:51], s63 offen lds
  v_mfma_f32_16x16x32_bf16 v[80:83], v[164:167], v[128:131], v[80:83]
  ds_read_b128 v[216:219], v25 offset:4096
  v_mfma_f32_16x16x32_bf16 v[84:87], v[164:167], v[132:135], v[84:87]
  s_add_u32 m0, s79, 19456
  v_mfma_f32_16x16x32_bf16 v[88:91], v[164:167], v[136:139], v[88:91]
  buffer_load_dwordx4 v11, s[48:51], s63 offen lds
  v_mfma_f32_16x16x32_bf16 v[92:95], v[164:167], v[140:143], v[92:95]
  ds_read_b128 v[220:223], v25 offset:6144
  v_mfma_f32_16x16x32_bf16 v[96:99], v[168:171], v[128:131], v[96:99]
  s_add_u32 m0, s79, 32768
  v_mfma_f32_16x16x32_bf16 v[100:103], v[168:171], v[132:135], v[100:103]
  buffer_load_dwordx4 v12, s[44:47], s64 offen lds
  v_mfma_f32_16x16x32_bf16 v[104:107], v[168:171], v[136:139], v[104:107]
  ds_read_b128 v[176:179], v21 offset:0
  v_mfma_f32_16x16x32_bf16 v[108:111], v[168:171], v[140:143], v[108:111]
  s_add_u32 m0, s79, 33792
  v_mfma_f32_16x16x32_bf16 v[112:115], v[172:175], v[128:131], v[112:115]
  buffer_load_dwordx4 v13, s[44:47], s64 offen lds
  v_mfma_f32_16x16x32_bf16 v[116:119], v[172:175], v[132:135], v[116:119]
  ds_read_b128 v[180:183], v21 offset:2048
  v_mfma_f32_16x16x32_bf16 v[120:123], v[172:175], v[136:139], v[120:123]
  s_add_u32 m0, s79, 34816
  v_mfma_f32_16x16x32_bf16 v[124:127], v[172:175], v[140:143], v[124:127]
  buffer_load_dwordx4 v14, s[44:47], s64 offen lds
  v_mfma_f32_16x16x32_bf16 v[64:67], v[160:163], v[144:147], v[64:67]
  ds_read_b128 v[184:187], v21 offset:4096
  v_mfma_f32_16x16x32_bf16 v[68:71], v[160:163], v[148:151], v[68:71]
  ds_read_b128 v[188:191], v21 offset:6144
  v_mfma_f32_16x16x32_bf16 v[72:75], v[160:163], v[152:155], v[72:75]
  s_add_u32 m0, s79, 35840
  v_mfma_f32_16x16x32_bf16 v[76:79], v[160:163], v[156:159], v[76:79]
  buffer_load_dwordx4 v15, s[44:47], s64 offen lds
  v_mfma_f32_16x16x32_bf16 v[80:83], v[164:167], v[144:147], v[80:83]
  ds_read_b128 v[192:195], v21 offset:16384
  v_mfma_f32_16x16x32_bf16 v[84:87], v[164:167], v[148:151], v[84:87]
  s_add_u32 s63, s63, 16384
  s_add_u32 s64, s64, 128
  s_add_u32 s65, s65, 1
  v_mfma_f32_16x16x32_bf16 v[88:91], v[164:167], v[152:155], v[88:91]
  ds_read_b128 v[196:199], v21 offset:18432
  v_mfma_f32_16x16x32_bf16 v[92:95], v[164:167], v[156:159], v[92:95]
  s_add_u32 s62, s62, 49152
  s_cmp_ge_u32 s62, 147456
  s_cselect_b32 s62, 0, s62
  v_mfma_f32_16x16x32_bf16 v[96:99], v[168:171], v[144:147], v[96:99]
  ds_read_b128 v[200:203], v21 offset:20480
  v_mfma_f32_16x16x32_bf16 v[100:103], v[168:171], v[148:151], v[100:103]
  s_cmp_eq_u32 s65, 16
  s_cselect_b32 s44, s16, s44
  s_cselect_b32 s45, s17, s45
  s_cselect_b32 s64, 0, s64
  v_mfma_f32_16x16x32_bf16 v[104:107], v[168:171], v[152:155], v[104:107]
  ds_read_b128 v[204:207], v21 offset:22528
  v_mfma_f32_16x16x32_bf16 v[108:111], v[168:171], v[156:159], v[108:111]
  s_cmp_ge_u32 s65, 32
  s_cselect_b32 s42, 0, s42
  s_cselect_b32 s46, 0, s46
  s_cselect_b32 s50, 0, s50
  v_mfma_f32_16x16x32_bf16 v[112:115], v[172:175], v[144:147], v[112:115]
  v_mfma_f32_16x16x32_bf16 v[116:119], v[172:175], v[148:151], v[116:119]
  v_mfma_f32_16x16x32_bf16 v[120:123], v[172:175], v[152:155], v[120:123]
  v_mfma_f32_16x16x32_bf16 v[124:127], v[172:175], v[156:159], v[124:127]
  s_waitcnt vmcnt(12) lgkmcnt(0)
  s_barrier
  v_mfma_f32_16x16x32_bf16 v[64:67], v[208:211], v[176:179], v[64:67]
  s_add_u32 s71, s71, 1
  s_cmp_ge_u32 s71, 3
  s_mov_b32 s72, 49152
  s_cselect_b32 s72, 4294868992, s72
  s_cselect_b32 s71, 0, s71
  v_add_u32 v20, s72, v20
  v_mfma_f32_16x16x32_bf16 v[68:71], v[208:211], v[180:183], v[68:71]
  v_add_u32 v21, s72, v21
  v_mfma_f32_16x16x32_bf16 v[72:75], v[208:211], v[184:187], v[72:75]
  v_add_u32 v24, s72, v24
  v_mfma_f32_16x16x32_bf16 v[76:79], v[208:211], v[188:191], v[76:79]
  v_add_u32 v25, s72, v25
  v_mfma_f32_16x16x32_bf16 v[80:83], v[212:215], v[176:179], v[80:83]
  ds_read_b128 v[160:163], v24 offset:0
  v_mfma_f32_16x16x32_bf16 v[84:87], v[212:215], v[180:183], v[84:87]
  ds_read_b128 v[164:167], v24 offset:2048
  v_mfma_f32_16x16x32_bf16 v[88:91], v[212:215], v[184:187], v[88:91]
  s_add_u32 s79, s62, s70
  s_add_u32 m0, s79, 0
  v_mfma_f32_16x16x32_bf16 v[92:95], v[212:215], v[188:191], v[92:95]
  buffer_load_dwordx4 v8, s[40:43], s63 offen lds
  v_mfma_f32_16x16x32_bf16 v[96:99], v[216:219], v[176:179], v[96:99]
  ds_read_b128 v[168:171], v24 offset:4096
  v_mfma_f32_16x16x32_bf16 v[100:103], v[216:219], v[180:183], v[100:103]
  ds_read_b128 v[172:175], v24 offset:6144
  v_mfma_f32_16x16x32_bf16 v[104:107], v[216:219], v[184:187], v[104:107]
  s_add_u32 m0, s79, 1024
  v_mfma_f32_16x16x32_bf16 v[108:111], v[216:219], v[188:191], v[108:111]
  buffer_load_dwordx4 v9, s[40:43], s63 offen lds
  v_mfma_f32_16x16x32_bf16 v[112:115], v[220:223], v[176:179], v[112:115]
  ds_read_b128 v[128:131], v20 offset:0
  v_mfma_f32_16x16x32_bf16 v[116:119], v[220:223], v[180:183], v[116:119]
  ds_read_b128 v[132:135], v20 offset:2048
  v_mfma_f32_16x16x32_bf16 v[120:123], v[220:223], v[184:187], v[120:123]
  s_add_u32 m0, s79, 2048
  v_mfma_f32_16x16x32_bf16 v[124:127], v[220:223], v[188:191], v[124:127]
  buffer_load_dwordx4 v10, s[40:43], s63 offen lds
  v_mfma_f32_16x16x32_bf16 v[64:67], v[208:211], v[192:195], v[64:67]
  ds_read_b128 v[136:139], v20 offset:4096
  v_mfma_f32_16x16x32_bf16 v[68:71], v[208:211], v[196:199], v[68:71]
  ds_read_b128 v[140:143], v20 offset:6144
  v_mfma_f32_16x16x32_bf16 v[72:75], v[208:211], v[200:203], v[72:75]
  s_add_u32 m0, s79, 3072
  v_mfma_f32_16x16x32_bf16 v[76:79], v[208:211], v[204:207], v[76:79]
  buffer_load_dwordx4 v11, s[40:43], s63 offen lds
  v_mfma_f32_16x16x32_bf16 v[80:83], v[212:215], v[192:195], v[80:83]
  ds_read_b128 v[144:147], v20 offset:16384
  v_mfma_f32_16x16x32_bf16 v[84:87], v[212:215], v[196:199], v[84:87]
  ds_read_b128 v[148:151], v20 offset:18432
  v_mfma_f32_16x16x32_bf16 v[88:91], v[212:215], v[200:203], v[88:91]
  s_add_u32 m0, s79, 16384
  v_mfma_f32_16x16x32_bf16 v[92:95], v[212:215], v[204:207], v[92:95]
  buffer_load_dwordx4 v8, s[48:51], s63 offen lds
  v_mfma_f32_16x16x32_bf16 v[96:99], v[216:219], v[192:195], v[96:99]
  ds_read_b128 v[152:155], v20 offset:20480
  v_mfma_f32_16x16x32_bf16 v[100:103], v[216:219], v[196:199], v[100:103]
  ds_read_b128 v[156:159], v20 offset:22528
  v_mfma_f32_16x16x32_bf16 v[104:107], v[216:219], v[200:203], v[104:107]
  s_add_u32 m0, s79, 17408
  v_mfma_f32_16x16x32_bf16 v[108:111], v[216:219], v[204:207], v[108:111]
  buffer_load_dwordx4 v9, s[48:51], s63 offen lds
  v_mfma_f32_16x16x32_bf16 v[112:115], v[220:223], v[192:195], v[112:115]
  v_mfma_f32_16x16x32_bf16 v[116:119], v[220:223], v[196:199], v[116:119]
  v_mfma_f32_16x16x32_bf16 v[120:123], v[220:223], v[200:203], v[120:123]
  v_mfma_f32_16x16x32_bf16 v[124:127], v[220:223], v[204:207], v[124:127]
  s_add_u32 s84, s84, 1
  s_cmp_lt_u32 s84, 32
  s_cbranch_scc1 K2_B_8
  v_lshlrev_b32 v192, 16, v44
  v_and_b32 v193, 0xffff0000, v44
  v_lshlrev_b32 v194, 16, v45
  v_and_b32 v195, 0xffff0000, v45
  v_lshlrev_b32 v196, 16, v46
  v_and_b32 v197, 0xffff0000, v46
  v_lshlrev_b32 v198, 16, v47
  v_and_b32 v199, 0xffff0000, v47
  v_lshlrev_b32 v200, 16, v48
  v_and_b32 v201, 0xffff0000, v48
  v_lshlrev_b32 v202, 16, v49
  v_and_b32 v203, 0xffff0000, v49
  v_lshlrev_b32 v204, 16, v50
  v_and_b32 v205, 0xffff0000, v50
  v_lshlrev_b32 v206, 16, v51
  v_and_b32 v207, 0xffff0000, v51
  v_lshlrev_b32 v52, 16, v224
  v_and_b32 v53, 0xffff0000, v224
  v_lshlrev_b32 v54, 16, v225
  v_and_b32 v55, 0xffff0000, v225
  v_pk_mul_f32 v[52:53], v[52:53], v[192:193]
  v_pk_mul_f32 v[54:55], v[54:55], v[194:195]
  v_cvt_pk_bf16_f32 v56, v52, v53
  v_cvt_pk_bf16_f32 v57, v54, v55
  v_lshlrev_b32 v52, 16, v56
  v_and_b32 v53, 0xffff0000, v56
  v_lshlrev_b32 v54, 16, v57
  v_and_b32 v55, 0xffff0000, v57
  v_fma_f32 v64, 2.0, v64, v52
  v_fma_f32 v65, 2.0, v65, v53
  v_fma_f32 v66, 2.0, v66, v54
  v_fma_f32 v67, 2.0, v67, v55
  v_mul_f32 v64, v64, v40
  v_mul_f32 v65, v65, v40
  v_mul_f32 v66, v66, v40
  v_mul_f32 v67, v67, v40
  v_lshlrev_b32 v52, 16, v226
  v_and_b32 v53, 0xffff0000, v226
  v_lshlrev_b32 v54, 16, v227
  v_and_b32 v55, 0xffff0000, v227
  v_pk_mul_f32 v[52:53], v[52:53], v[196:197]
  v_pk_mul_f32 v[54:55], v[54:55], v[198:199]
  v_cvt_pk_bf16_f32 v56, v52, v53
  v_cvt_pk_bf16_f32 v57, v54, v55
  v_lshlrev_b32 v52, 16, v56
  v_and_b32 v53, 0xffff0000, v56
  v_lshlrev_b32 v54, 16, v57
  v_and_b32 v55, 0xffff0000, v57
  v_fma_f32 v80, 2.0, v80, v52
  v_fma_f32 v81, 2.0, v81, v53
  v_fma_f32 v82, 2.0, v82, v54
  v_fma_f32 v83, 2.0, v83, v55
  v_mul_f32 v80, v80, v40
  v_mul_f32 v81, v81, v40
  v_mul_f32 v82, v82, v40
  v_mul_f32 v83, v83, v40
  v_lshlrev_b32 v52, 16, v228
  v_and_b32 v53, 0xffff0000, v228
  v_lshlrev_b32 v54, 16, v229
  v_and_b32 v55, 0xffff0000, v229
  v_pk_mul_f32 v[52:53], v[52:53], v[200:201]
  v_pk_mul_f32 v[54:55], v[54:55], v[202:203]
  v_cvt_pk_bf16_f32 v56, v52, v53
  v_cvt_pk_bf16_f32 v57, v54, v55
  v_lshlrev_b32 v52, 16, v56
  v_and_b32 v53, 0xffff0000, v56
  v_lshlrev_b32 v54, 16, v57
  v_and_b32 v55, 0xffff0000, v57
  v_fma_f32 v96, 2.0, v96, v52
  v_fma_f32 v97, 2.0, v97, v53
  v_fma_f32 v98, 2.0, v98, v54
  v_fma_f32 v99, 2.0, v99, v55
  v_mul_f32 v96, v96, v40
  v_mul_f32 v97, v97, v40
  v_mul_f32 v98, v98, v40
  v_mul_f32 v99, v99, v40
  v_lshlrev_b32 v52, 16, v230
  v_and_b32 v53, 0xffff0000, v230
  v_lshlrev_b32 v54, 16, v231
  v_and_b32 v55, 0xffff0000, v231
  v_pk_mul_f32 v[52:53], v[52:53], v[204:205]
  v_pk_mul_f32 v[54:55], v[54:55], v[206:207]
  v_cvt_pk_bf16_f32 v56, v52, v53
  v_cvt_pk_bf16_f32 v57, v54, v55
  v_lshlrev_b32 v52, 16, v56
  v_and_b32 v53, 0xffff0000, v56
  v_lshlrev_b32 v54, 16, v57
  v_and_b32 v55, 0xffff0000, v57
  v_fma_f32 v112, 2.0, v112, v52
  v_fma_f32 v113, 2.0, v113, v53
  v_fma_f32 v114, 2.0, v114, v54
  v_fma_f32 v115, 2.0, v115, v55
  v_mul_f32 v112, v112, v40
  v_mul_f32 v113, v113, v40
  v_mul_f32 v114, v114, v40
  v_mul_f32 v115, v115, v40
  v_lshlrev_b32 v52, 16, v232
  v_and_b32 v53, 0xffff0000, v232
  v_lshlrev_b32 v54, 16, v233
  v_and_b32 v55, 0xffff0000, v233
  v_pk_mul_f32 v[52:53], v[52:53], v[192:193]
  v_pk_mul_f32 v[54:55], v[54:55], v[194:195]
  v_cvt_pk_bf16_f32 v56, v52, v53
  v_cvt_pk_bf16_f32 v57, v54, v55
  v_lshlrev_b32 v52, 16, v56
  v_and_b32 v53, 0xffff0000, v56
  v_lshlrev_b32 v54, 16, v57
  v_and_b32 v55, 0xffff0000, v57
  v_fma_f32 v68, 2.0, v68, v52
  v_fma_f32 v69, 2.0, v69, v53
  v_fma_f32 v70, 2.0, v70, v54
  v_fma_f32 v71, 2.0, v71, v55
  v_mul_f32 v68, v68, v41
  v_mul_f32 v69, v69, v41
  v_mul_f32 v70, v70, v41
  v_mul_f32 v71, v71, v41
  v_lshlrev_b32 v52, 16, v234
  v_and_b32 v53, 0xffff0000, v234
  v_lshlrev_b32 v54, 16, v235
  v_and_b32 v55, 0xffff0000, v235
  v_pk_mul_f32 v[52:53], v[52:53], v[196:197]
  v_pk_mul_f32 v[54:55], v[54:55], v[198:199]
  v_cvt_pk_bf16_f32 v56, v52, v53
  v_cvt_pk_bf16_f32 v57, v54, v55
  v_lshlrev_b32 v52, 16, v56
  v_and_b32 v53, 0xffff0000, v56
  v_lshlrev_b32 v54, 16, v57
  v_and_b32 v55, 0xffff0000, v57
  v_fma_f32 v84, 2.0, v84, v52
  v_fma_f32 v85, 2.0, v85, v53
  v_fma_f32 v86, 2.0, v86, v54
  v_fma_f32 v87, 2.0, v87, v55
  v_mul_f32 v84, v84, v41
  v_mul_f32 v85, v85, v41
  v_mul_f32 v86, v86, v41
  v_mul_f32 v87, v87, v41
  v_lshlrev_b32 v52, 16, v236
  v_and_b32 v53, 0xffff0000, v236
  v_lshlrev_b32 v54, 16, v237
  v_and_b32 v55, 0xffff0000, v237
  v_pk_mul_f32 v[52:53], v[52:53], v[200:201]
  v_pk_mul_f32 v[54:55], v[54:55], v[202:203]
  v_cvt_pk_bf16_f32 v56, v52, v53
  v_cvt_pk_bf16_f32 v57, v54, v55
  v_lshlrev_b32 v52, 16, v56
  v_and_b32 v53, 0xffff0000, v56
  v_lshlrev_b32 v54, 16, v57
  v_and_b32 v55, 0xffff0000, v57
  v_fma_f32 v100, 2.0, v100, v52
  v_fma_f32 v101, 2.0, v101, v53
  v_fma_f32 v102, 2.0, v102, v54
  v_fma_f32 v103, 2.0, v103, v55
  v_mul_f32 v100, v100, v41
  v_mul_f32 v101, v101, v41
  v_mul_f32 v102, v102, v41
  v_mul_f32 v103, v103, v41
  v_lshlrev_b32 v52, 16, v238
  v_and_b32 v53, 0xffff0000, v238
  v_lshlrev_b32 v54, 16, v239
  v_and_b32 v55, 0xffff0000, v239
  v_pk_mul_f32 v[52:53], v[52:53], v[204:205]
  v_pk_mul_f32 v[54:55], v[54:55], v[206:207]
  v_cvt_pk_bf16_f32 v56, v52, v53
  v_cvt_pk_bf16_f32 v57, v54, v55
  v_lshlrev_b32 v52, 16, v56
  v_and_b32 v53, 0xffff0000, v56
  v_lshlrev_b32 v54, 16, v57
  v_and_b32 v55, 0xffff0000, v57
  v_fma_f32 v116, 2.0, v116, v52
  v_fma_f32 v117, 2.0, v117, v53
  v_fma_f32 v118, 2.0, v118, v54
  v_fma_f32 v119, 2.0, v119, v55
  v_mul_f32 v116, v116, v41
  v_mul_f32 v117, v117, v41
  v_mul_f32 v118, v118, v41
  v_mul_f32 v119, v119, v41
  v_lshlrev_b32 v52, 16, v240
  v_and_b32 v53, 0xffff0000, v240
  v_lshlrev_b32 v54, 16, v241
  v_and_b32 v55, 0xffff0000, v241
  v_pk_mul_f32 v[52:53], v[52:53], v[192:193]
  v_pk_mul_f32 v[54:55], v[54:55], v[194:195]
  v_cvt_pk_bf16_f32 v56, v52, v53
  v_cvt_pk_bf16_f32 v57, v54, v55
  v_lshlrev_b32 v52, 16, v56
  v_and_b32 v53, 0xffff0000, v56
  v_lshlrev_b32 v54, 16, v57
  v_and_b32 v55, 0xffff0000, v57
  v_fma_f32 v72, 2.0, v72, v52
  v_fma_f32 v73, 2.0, v73, v53
  v_fma_f32 v74, 2.0, v74, v54
  v_fma_f32 v75, 2.0, v75, v55
  v_mul_f32 v72, v72, v42
  v_mul_f32 v73, v73, v42
  v_mul_f32 v74, v74, v42
  v_mul_f32 v75, v75, v42
  v_lshlrev_b32 v52, 16, v242
  v_and_b32 v53, 0xffff0000, v242
  v_lshlrev_b32 v54, 16, v243
  v_and_b32 v55, 0xffff0000, v243
  v_pk_mul_f32 v[52:53], v[52:53], v[196:197]
  v_pk_mul_f32 v[54:55], v[54:55], v[198:199]
  v_cvt_pk_bf16_f32 v56, v52, v53
  v_cvt_pk_bf16_f32 v57, v54, v55
  v_lshlrev_b32 v52, 16, v56
  v_and_b32 v53, 0xffff0000, v56
  v_lshlrev_b32 v54, 16, v57
  v_and_b32 v55, 0xffff0000, v57
  v_fma_f32 v88, 2.0, v88, v52
  v_fma_f32 v89, 2.0, v89, v53
  v_fma_f32 v90, 2.0, v90, v54
  v_fma_f32 v91, 2.0, v91, v55
  v_mul_f32 v88, v88, v42
  v_mul_f32 v89, v89, v42
  v_mul_f32 v90, v90, v42
  v_mul_f32 v91, v91, v42
  v_lshlrev_b32 v52, 16, v244
  v_and_b32 v53, 0xffff0000, v244
  v_lshlrev_b32 v54, 16, v245
  v_and_b32 v55, 0xffff0000, v245
  v_pk_mul_f32 v[52:53], v[52:53], v[200:201]
  v_pk_mul_f32 v[54:55], v[54:55], v[202:203]
  v_cvt_pk_bf16_f32 v56, v52, v53
  v_cvt_pk_bf16_f32 v57, v54, v55
  v_lshlrev_b32 v52, 16, v56
  v_and_b32 v53, 0xffff0000, v56
  v_lshlrev_b32 v54, 16, v57
  v_and_b32 v55, 0xffff0000, v57
  v_fma_f32 v104, 2.0, v104, v52
  v_fma_f32 v105, 2.0, v105, v53
  v_fma_f32 v106, 2.0, v106, v54
  v_fma_f32 v107, 2.0, v107, v55
  v_mul_f32 v104, v104, v42
  v_mul_f32 v105, v105, v42
  v_mul_f32 v106, v106, v42
  v_mul_f32 v107, v107, v42
  v_lshlrev_b32 v52, 16, v246
  v_and_b32 v53, 0xffff0000, v246
  v_lshlrev_b32 v54, 16, v247
  v_and_b32 v55, 0xffff0000, v247
  v_pk_mul_f32 v[52:53], v[52:53], v[204:205]
  v_pk_mul_f32 v[54:55], v[54:55], v[206:207]
  v_cvt_pk_bf16_f32 v56, v52, v53
  v_cvt_pk_bf16_f32 v57, v54, v55
  v_lshlrev_b32 v52, 16, v56
  v_and_b32 v53, 0xffff0000, v56
  v_lshlrev_b32 v54, 16, v57
  v_and_b32 v55, 0xffff0000, v57
  v_fma_f32 v120, 2.0, v120, v52
  v_fma_f32 v121, 2.0, v121, v53
  v_fma_f32 v122, 2.0, v122, v54
  v_fma_f32 v123, 2.0, v123, v55
  v_mul_f32 v120, v120, v42
  v_mul_f32 v121, v121, v42
  v_mul_f32 v122, v122, v42
  v_mul_f32 v123, v123, v42
  v_lshlrev_b32 v52, 16, v248
  v_and_b32 v53, 0xffff0000, v248
  v_lshlrev_b32 v54, 16, v249
  v_and_b32 v55, 0xffff0000, v249
  v_pk_mul_f32 v[52:53], v[52:53], v[192:193]
  v_pk_mul_f32 v[54:55], v[54:55], v[194:195]
  v_cvt_pk_bf16_f32 v56, v52, v53
  v_cvt_pk_bf16_f32 v57, v54, v55
  v_lshlrev_b32 v52, 16, v56
  v_and_b32 v53, 0xffff0000, v56
  v_lshlrev_b32 v54, 16, v57
  v_and_b32 v55, 0xffff0000, v57
  v_fma_f32 v76, 2.0, v76, v52
  v_fma_f32 v77, 2.0, v77, v53
  v_fma_f32 v78, 2.0, v78, v54
  v_fma_f32 v79, 2.0, v79, v55
  v_mul_f32 v76, v76, v43
  v_mul_f32 v77, v77, v43
  v_mul_f32 v78, v78, v43
  v_mul_f32 v79, v79, v43
  v_lshlrev_b32 v52, 16, v250
  v_and_b32 v53, 0xffff0000, v250
  v_lshlrev_b32 v54, 16, v251
  v_and_b32 v55, 0xffff0000, v251
  v_pk_mul_f32 v[52:53], v[52:53], v[196:197]
  v_pk_mul_f32 v[54:55], v[54:55], v[198:199]
  v_cvt_pk_bf16_f32 v56, v52, v53
  v_cvt_pk_bf16_f32 v57, v54, v55
  v_lshlrev_b32 v52, 16, v56
  v_and_b32 v53, 0xffff0000, v56
  v_lshlrev_b32 v54, 16, v57
  v_and_b32 v55, 0xffff0000, v57
  v_fma_f32 v92, 2.0, v92, v52
  v_fma_f32 v93, 2.0, v93, v53
  v_fma_f32 v94, 2.0, v94, v54
  v_fma_f32 v95, 2.0, v95, v55
  v_mul_f32 v92, v92, v43
  v_mul_f32 v93, v93, v43
  v_mul_f32 v94, v94, v43
  v_mul_f32 v95, v95, v43
  v_lshlrev_b32 v52, 16, v252
  v_and_b32 v53, 0xffff0000, v252
  v_lshlrev_b32 v54, 16, v253
  v_and_b32 v55, 0xffff0000, v253
  v_pk_mul_f32 v[52:53], v[52:53], v[200:201]
  v_pk_mul_f32 v[54:55], v[54:55], v[202:203]
  v_cvt_pk_bf16_f32 v56, v52, v53
  v_cvt_pk_bf16_f32 v57, v54, v55
  v_lshlrev_b32 v52, 16, v56
  v_and_b32 v53, 0xffff0000, v56
  v_lshlrev_b32 v54, 16, v57
  v_and_b32 v55, 0xffff0000, v57
  v_fma_f32 v108, 2.0, v108, v52
  v_fma_f32 v109, 2.0, v109, v53
  v_fma_f32 v110, 2.0, v110, v54
  v_fma_f32 v111, 2.0, v111, v55
  v_mul_f32 v108, v108, v43
  v_mul_f32 v109, v109, v43
  v_mul_f32 v110, v110, v43
  v_mul_f32 v111, v111, v43
  v_lshlrev_b32 v52, 16, v254
  v_and_b32 v53, 0xffff0000, v254
  v_lshlrev_b32 v54, 16, v255
  v_and_b32 v55, 0xffff0000, v255
  v_pk_mul_f32 v[52:53], v[52:53], v[204:205]
  v_pk_mul_f32 v[54:55], v[54:55], v[206:207]
  v_cvt_pk_bf16_f32 v56, v52, v53
  v_cvt_pk_bf16_f32 v57, v54, v55
  v_lshlrev_b32 v52, 16, v56
  v_and_b32 v53, 0xffff0000, v56
  v_lshlrev_b32 v54, 16, v57
  v_and_b32 v55, 0xffff0000, v57
  v_fma_f32 v124, 2.0, v124, v52
  v_fma_f32 v125, 2.0, v125, v53
  v_fma_f32 v126, 2.0, v126, v54
  v_fma_f32 v127, 2.0, v127, v55
  v_mul_f32 v124, v124, v43
  v_mul_f32 v125, v125, v43
  v_mul_f32 v126, v126, v43
  v_mul_f32 v127, v127, v43
  s_mov_b32 s48, s34
  s_mov_b32 s49, s35
  s_mov_b32 s50, 0x100
  s_mov_b32 s51, 0x00020000
  s_add_u32 s52, s36, 0x2000000
  s_addc_u32 s53, s37, 0
  s_mov_b32 s54, 0x400000
  s_mov_b32 s55, 0x00020000
  s_lshr_b32 s74, s60, 1
  s_lshl_b32 s74, s74, 2
  s_and_b32 s75, s60, 1
  s_lshl_b32 s75, 1, s75
  s_mov_b32 s78, 0
  v_mov_b32 v37, 0
K2_poll_9:
  buffer_load_dword v38, v37, s[48:51], s74 offen sc1
  s_waitcnt vmcnt(0)
  v_readfirstlane_b32 s79, v38
  s_add_u32 s78, s78, 1
  s_and_b32 s79, s79, s75
  s_cbranch_scc1 K2_got_10
  s_cmp_gt_u32 s78, 0x100000
  s_cbranch_scc1 K2_got_10
  s_sleep 1
  s_branch K2_poll_9
K2_got_10:
  s_mov_b32 s74, 0
  buffer_load_dwordx2 v[160:161], v36, s[52:55], s74 offen offset:0 sc0 sc1
  s_mov_b32 s74, 0
  buffer_load_dwordx2 v[162:163], v36, s[52:55], s74 offen offset:32 sc0 sc1
  s_mov_b32 s74, 0
  buffer_load_dwordx2 v[164:165], v36, s[52:55], s74 offen offset:64 sc0 sc1
  s_mov_b32 s74, 0
  buffer_load_dwordx2 v[166:167], v36, s[52:55], s74 offen offset:96 sc0 sc1
  s_mov_b32 s74, 32768
  buffer_load_dwordx2 v[168:169], v36, s[52:55], s74 offen offset:0 sc0 sc1
  s_mov_b32 s74, 32768
  buffer_load_dwordx2 v[170:171], v36, s[52:55], s74 offen offset:32 sc0 sc1
  s_mov_b32 s74, 32768
  buffer_load_dwordx2 v[172:173], v36, s[52:55], s74 offen offset:64 sc0 sc1
  s_mov_b32 s74, 32768
  buffer_load_dwordx2 v[174:175], v36, s[52:55], s74 offen offset:96 sc0 sc1
  s_mov_b32 s74, 65536
  buffer_load_dwordx2 v[176:177], v36, s[52:55], s74 offen offset:0 sc0 sc1
  s_mov_b32 s74, 65536
  buffer_load_dwordx2 v[178:179], v36, s[52:55], s74 offen offset:32 sc0 sc1
  s_mov_b32 s74, 65536
  buffer_load_dwordx2 v[180:181], v36, s[52:55], s74 offen offset:64 sc0 sc1
  s_mov_b32 s74, 65536
  buffer_load_dwordx2 v[182:183], v36, s[52:55], s74 offen offset:96 sc0 sc1
  s_mov_b32 s74, 98304
  buffer_load_dwordx2 v[184:185], v36, s[52:55], s74 offen offset:0 sc0 sc1
  s_mov_b32 s74, 98304
  buffer_load_dwordx2 v[186:187], v36, s[52:55], s74 offen offset:32 sc0 sc1
  s_mov_b32 s74, 98304
  buffer_load_dwordx2 v[188:189], v36, s[52:55], s74 offen offset:64 sc0 sc1
  s_mov_b32 s74, 98304
  buffer_load_dwordx2 v[190:191], v36, s[52:55], s74 offen offset:96 sc0 sc1
  s_mov_b32 s48, s32
  s_mov_b32 s49, s33
  s_mov_b32 s50, 0x800000
  s_mov_b32 s51, 0x00020000
  v_lshlrev_b32 v36, 1, v36
  s_waitcnt vmcnt(15)
  v_lshlrev_b32 v56, 16, v160
  v_and_b32 v57, 0xffff0000, v160
  v_lshlrev_b32 v58, 16, v161
  v_and_b32 v59, 0xffff0000, v161
  v_pk_add_f32 v[64:65], v[64:65], v[56:57]
  v_pk_add_f32 v[66:67], v[66:67], v[58:59]
  s_mov_b32 s74, 0
  buffer_store_dwordx4 v[64:67], v36, s[48:51], s74 offen offset:0
  s_waitcnt vmcnt(15)
  v_lshlrev_b32 v56, 16, v162
  v_and_b32 v57, 0xffff0000, v162
  v_lshlrev_b32 v58, 16, v163
  v_and_b32 v59, 0xffff0000, v163
  v_pk_add_f32 v[80:81], v[80:81], v[56:57]
  v_pk_add_f32 v[82:83], v[82:83], v[58:59]
  s_mov_b32 s74, 0
  buffer_store_dwordx4 v[80:83], v36, s[48:51], s74 offen offset:64
  s_waitcnt vmcnt(15)
  v_lshlrev_b32 v56, 16, v164
  v_and_b32 v57, 0xffff0000, v164
  v_lshlrev_b32 v58, 16, v165
  v_and_b32 v59, 0xffff0000, v165
  v_pk_add_f32 v[96:97], v[96:97], v[56:57]
  v_pk_add_f32 v[98:99], v[98:99], v[58:59]
  s_mov_b32 s74, 0
  buffer_store_dwordx4 v[96:99], v36, s[48:51], s74 offen offset:128
  s_waitcnt vmcnt(15)
  v_lshlrev_b32 v56, 16, v166
  v_and_b32 v57, 0xffff0000, v166
  v_lshlrev_b32 v58, 16, v167
  v_and_b32 v59, 0xffff0000, v167
  v_pk_add_f32 v[112:113], v[112:113], v[56:57]
  v_pk_add_f32 v[114:115], v[114:115], v[58:59]
  s_mov_b32 s74, 0
  buffer_store_dwordx4 v[112:115], v36, s[48:51], s74 offen offset:192
  s_waitcnt vmcnt(15)
  v_lshlrev_b32 v56, 16, v168
  v_and_b32 v57, 0xffff0000, v168
  v_lshlrev_b32 v58, 16, v169
  v_and_b32 v59, 0xffff0000, v169
  v_pk_add_f32 v[68:69], v[68:69], v[56:57]
  v_pk_add_f32 v[70:71], v[70:71], v[58:59]
  s_mov_b32 s74, 65536
  buffer_store_dwordx4 v[68:71], v36, s[48:51], s74 offen offset:0
  s_waitcnt vmcnt(15)
  v_lshlrev_b32 v56, 16, v170
  v_and_b32 v57, 0xffff0000, v170
  v_lshlrev_b32 v58, 16, v171
  v_and_b32 v59, 0xffff0000, v171
  v_pk_add_f32 v[84:85], v[84:85], v[56:57]
  v_pk_add_f32 v[86:87], v[86:87], v[58:59]
  s_mov_b32 s74, 65536
  buffer_store_dwordx4 v[84:87], v36, s[48:51], s74 offen offset:64
  s_waitcnt vmcnt(15)
  v_lshlrev_b32 v56, 16, v172
  v_and_b32 v57, 0xffff0000, v172
  v_lshlrev_b32 v58, 16, v173
  v_and_b32 v59, 0xffff0000, v173
  v_pk_add_f32 v[100:101], v[100:101], v[56:57]
  v_pk_add_f32 v[102:103], v[102:103], v[58:59]
  s_mov_b32 s74, 65536
  buffer_store_dwordx4 v[100:103], v36, s[48:51], s74 offen offset:128
  s_waitcnt vmcnt(15)
  v_lshlrev_b32 v56, 16, v174
  v_and_b32 v57, 0xffff0000, v174
  v_lshlrev_b32 v58, 16, v175
  v_and_b32 v59, 0xffff0000, v175
  v_pk_add_f32 v[116:117], v[116:117], v[56:57]
  v_pk_add_f32 v[118:119], v[118:119], v[58:59]
  s_mov_b32 s74, 65536
  buffer_store_dwordx4 v[116:119], v36, s[48:51], s74 offen offset:192
  s_waitcnt vmcnt(15)
  v_lshlrev_b32 v56, 16, v176
  v_and_b32 v57, 0xffff0000, v176
  v_lshlrev_b32 v58, 16, v177
  v_and_b32 v59, 0xffff0000, v177
  v_pk_add_f32 v[72:73], v[72:73], v[56:57]
  v_pk_add_f32 v[74:75], v[74:75], v[58:59]
  s_mov_b32 s74, 131072
  buffer_store_dwordx4 v[72:75], v36, s[48:51], s74 offen offset:0
  s_waitcnt vmcnt(15)
  v_lshlrev_b32 v56, 16, v178
  v_and_b32 v57, 0xffff0000, v178
  v_lshlrev_b32 v58, 16, v179
  v_and_b32 v59, 0xffff0000, v179
  v_pk_add_f32 v[88:89], v[88:89], v[56:57]
  v_pk_add_f32 v[90:91], v[90:91], v[58:59]
  s_mov_b32 s74, 131072
  buffer_store_dwordx4 v[88:91], v36, s[48:51], s74 offen offset:64
  s_waitcnt vmcnt(15)
  v_lshlrev_b32 v56, 16, v180
  v_and_b32 v57, 0xffff0000, v180
  v_lshlrev_b32 v58, 16, v181
  v_and_b32 v59, 0xffff0000, v181
  v_pk_add_f32 v[104:105], v[104:105], v[56:57]
  v_pk_add_f32 v[106:107], v[106:107], v[58:59]
  s_mov_b32 s74, 131072
  buffer_store_dwordx4 v[104:107], v36, s[48:51], s74 offen offset:128
  s_waitcnt vmcnt(15)
  v_lshlrev_b32 v56, 16, v182
  v_and_b32 v57, 0xffff0000, v182
  v_lshlrev_b32 v58, 16, v183
  v_and_b32 v59, 0xffff0000, v183
  v_pk_add_f32 v[120:121], v[120:121], v[56:57]
  v_pk_add_f32 v[122:123], v[122:123], v[58:59]
  s_mov_b32 s74, 131072
  buffer_store_dwordx4 v[120:123], v36, s[48:51], s74 offen offset:192
  s_waitcnt vmcnt(15)
  v_lshlrev_b32 v56, 16, v184
  v_and_b32 v57, 0xffff0000, v184
  v_lshlrev_b32 v58, 16, v185
  v_and_b32 v59, 0xffff0000, v185
  v_pk_add_f32 v[76:77], v[76:77], v[56:57]
  v_pk_add_f32 v[78:79], v[78:79], v[58:59]
  s_mov_b32 s74, 196608
  buffer_store_dwordx4 v[76:79], v36, s[48:51], s74 offen offset:0
  s_waitcnt vmcnt(15)
  v_lshlrev_b32 v56, 16, v186
  v_and_b32 v57, 0xffff0000, v186
  v_lshlrev_b32 v58, 16, v187
  v_and_b32 v59, 0xffff0000, v187
  v_pk_add_f32 v[92:93], v[92:93], v[56:57]
  v_pk_add_f32 v[94:95], v[94:95], v[58:59]
  s_mov_b32 s74, 196608
  buffer_store_dwordx4 v[92:95], v36, s[48:51], s74 offen offset:64
  s_waitcnt vmcnt(15)
  v_lshlrev_b32 v56, 16, v188
  v_and_b32 v57, 0xffff0000, v188
  v_lshlrev_b32 v58, 16, v189
  v_and_b32 v59, 0xffff0000, v189
  v_pk_add_f32 v[108:109], v[108:109], v[56:57]
  v_pk_add_f32 v[110:111], v[110:111], v[58:59]
  s_mov_b32 s74, 196608
  buffer_store_dwordx4 v[108:111], v36, s[48:51], s74 offen offset:128
  s_waitcnt vmcnt(15)
  v_lshlrev_b32 v56, 16, v190
  v_and_b32 v57, 0xffff0000, v190
  v_lshlrev_b32 v58, 16, v191
  v_and_b32 v59, 0xffff0000, v191
  v_pk_add_f32 v[124:125], v[124:125], v[56:57]
  v_pk_add_f32 v[126:127], v[126:127], v[58:59]
  s_mov_b32 s74, 196608
  buffer_store_dwordx4 v[124:127], v36, s[48:51], s74 offen offset:192
K2_end:
  s_endpgm
.section .rodata,"a"
.p2align 6
.amdhsa_kernel gm_phase1_kernel
  .amdhsa_next_free_vgpr 512
  .amdhsa_next_free_sgpr 102
  .amdhsa_accum_offset 256
  .amdhsa_group_segment_fixed_size 0
  .amdhsa_kernarg_size 136
  .amdhsa_user_sgpr_count 2
  .amdhsa_user_sgpr_kernarg_segment_ptr 1
  .amdhsa_system_sgpr_workgroup_id_x 1
.end_amdhsa_kernel
.p2align 6
.amdhsa_kernel gm_phase2_kernel
  .amdhsa_next_free_vgpr 256
  .amdhsa_next_free_sgpr 102
  .amdhsa_accum_offset 256
  .amdhsa_group_segment_fixed_size 0
  .amdhsa_kernarg_size 136
  .amdhsa_user_sgpr_count 2
  .amdhsa_user_sgpr_kernarg_segment_ptr 1
  .amdhsa_system_sgpr_workgroup_id_x 1
.end_amdhsa_kernel
```
